```python
import torch

def _softmax(x, axis=-1):
    return torch.softmax(x, dim=axis)
def _gelu(x):
    return torch.nn.functional.gelu(x, approximate="tanh")
def _silu(x):
    return torch.nn.functional.silu(x)
def _sigmoid(x):
    return torch.sigmoid(x)
def _layernorm(x, axis=-1, eps=1e-5):
    m = x.mean(dim=axis, keepdim=True)
    v = x.var(dim=axis, keepdim=True, unbiased=False)
    return (x - m) / torch.sqrt(v + eps)
def _scatter_add(tgt, idx, src, axis=0):
    return tgt.clone().index_add_(axis, idx, src)
def _segment_sum(src, seg, n):
    out = torch.zeros((n,) + src.shape[1:], dtype=src.dtype)
    return out.index_add_(0, seg, src)
def _pad(x, pw):
    flat = tuple(v for pair in reversed(pw) for v in pair)
    return torch.nn.functional.pad(x, flat)

kernel_name = 'concat_heads__ssm_conv_h3__ssm_conv_h3__prompt'

def setup_inputs():

    _w = (lambda a: (lambda t: t.to(torch.bfloat16) if t.is_floating_point() else t)(torch.as_tensor(a)))
    def _A_setup():
        B, S, D = 1, 2048, 640
        ks = 4
        return {
            "q": _w((lambda *s: torch.randn(*s, dtype=torch.bfloat16) * 0.05)(B, S, D)),
            "k": _w((lambda *s: torch.randn(*s, dtype=torch.bfloat16) * 0.05)(B, S, D)),
            "v": _w((lambda *s: torch.randn(*s, dtype=torch.bfloat16) * 0.05)(B, S, D)),
            "shift_k": _w((lambda *s: torch.randn(*s, dtype=torch.bfloat16) * 0.05)(D, ks) * 0.5),
            "ssm_k": _w((lambda *s: torch.randn(*s, dtype=torch.bfloat16) * 0.05)(D, S) * (1.0 / S ** 0.5)),
            "ssm_D": _w((lambda *s: torch.randn(*s, dtype=torch.bfloat16) * 0.05)(D)),
        }
    _A_in = _A_setup()

    def _B_setup():
        B, S, D = 1, 2048, 640
        ks = 4
        return {
            "q": _w((lambda *s: torch.randn(*s, dtype=torch.bfloat16) * 0.05)(B, S, D)),
            "k": _w((lambda *s: torch.randn(*s, dtype=torch.bfloat16) * 0.05)(B, S, D)),
            "v": _w((lambda *s: torch.randn(*s, dtype=torch.bfloat16) * 0.05)(B, S, D)),
            "shift_k": _w((lambda *s: torch.randn(*s, dtype=torch.bfloat16) * 0.05)(D, ks) * 0.5),
            "ssm_k": _w((lambda *s: torch.randn(*s, dtype=torch.bfloat16) * 0.05)(D, S) * (1.0 / S ** 0.5)),
            "ssm_D": _w((lambda *s: torch.randn(*s, dtype=torch.bfloat16) * 0.05)(D)),
        }
    _B_in = _B_setup()

    return {
        "A_q": _A_in["q"],
        "A_k": _A_in["k"],
        "A_v": _A_in["v"],
        "A_shift_k": _A_in["shift_k"],
        "A_ssm_k": _A_in["ssm_k"],
        "A_ssm_D": _A_in["ssm_D"],
        "B_q": _B_in["q"],
        "B_k": _B_in["k"],
        "B_v": _B_in["v"],
        "B_shift_k": _B_in["shift_k"],
        "B_ssm_k": _B_in["ssm_k"],
        "B_ssm_D": _B_in["ssm_D"],
    }

def reference(A_q, A_k, A_v, A_shift_k, A_ssm_k, A_ssm_D, B_q, B_k, B_v, B_shift_k, B_ssm_k, B_ssm_D):
    def _A_ref(q, k, v, shift_k, ssm_k, ssm_D):
        B, S, D = q.shape
        ks = shift_k.shape[-1]
        k_pad = _pad(k, ((0, 0), (ks - 1, 0), (0, 0)))
        k_shift = torch.zeros_like(k)
        for t in range(ks):
            k_shift = k_shift + k_pad[:, t:t + S, :] * shift_k[:, ks - 1 - t][None, None, :]
        kv = k_shift * v
        L = 2 * S
        kv_pad = _pad(kv, ((0, 0), (0, S), (0, 0)))
        kf_pad = _pad(ssm_k, ((0, 0), (0, S)))
        kv_f = (lambda x, axes=(-2,-1): torch.fft.rfft2(x.float(), dim=axes))(kv_pad[:, None, :, :], axes=(1, 2))
        kf_f = (lambda x, axes=(-2,-1): torch.fft.rfft2(x.float(), dim=axes))(kf_pad[:, None, :], axes=(1, 2))
        kf_f = (lambda x, *d: x.permute(*d))(kf_f, 1, 2, 0)
        y_f = kv_f * kf_f[None, :, :, :]
        y = (lambda x, s, axes=(-2,-1): torch.fft.irfft2(x, s=s, dim=axes).to(torch.bfloat16))(y_f, (1, L), axes=(1, 2))[:, 0, :S, :]
        y = y + kv * ssm_D[None, None, :]
        return q * y

    def _B_ref(q, k, v, shift_k, ssm_k, ssm_D):
        B, S, D = q.shape
        ks = shift_k.shape[-1]
        k_pad = _pad(k, ((0, 0), (ks - 1, 0), (0, 0)))
        k_shift = torch.zeros_like(k)
        for t in range(ks):
            k_shift = k_shift + k_pad[:, t:t + S, :] * shift_k[:, ks - 1 - t][None, None, :]
        kv = k_shift * v
        L = 2 * S
        kv_pad = _pad(kv, ((0, 0), (0, S), (0, 0)))
        kf_pad = _pad(ssm_k, ((0, 0), (0, S)))
        kv_f = (lambda x, axes=(-2,-1): torch.fft.rfft2(x.float(), dim=axes))(kv_pad[:, None, :, :], axes=(1, 2))
        kf_f = (lambda x, axes=(-2,-1): torch.fft.rfft2(x.float(), dim=axes))(kf_pad[:, None, :], axes=(1, 2))
        kf_f = (lambda x, *d: x.permute(*d))(kf_f, 1, 2, 0)
        y_f = kv_f * kf_f[None, :, :, :]
        y = (lambda x, s, axes=(-2,-1): torch.fft.irfft2(x, s=s, dim=axes).to(torch.bfloat16))(y_f, (1, L), axes=(1, 2))[:, 0, :S, :]
        y = y + kv * ssm_D[None, None, :]
        return q * y

    a = _A_ref(A_q, A_k, A_v, A_shift_k, A_ssm_k, A_ssm_D)
    b = _B_ref(B_q, B_k, B_v, B_shift_k, B_ssm_k, B_ssm_D)
    return torch.concatenate([a, b], axis=-1)
```

```asm
; @launch grid=(256,1,1) block=(512,1,1) lds=138112
.amdgcn_target "amdgcn-amd-amdhsa--gfx950"
.text
.globl concat_heads__ssm_conv_h3__ssm_conv_h3__prompt_kernel
.p2align 8
.type concat_heads__ssm_conv_h3__ssm_conv_h3__prompt_kernel,@function
concat_heads__ssm_conv_h3__ssm_conv_h3__prompt_kernel:
    s_cmp_ge_u32 s2, 256
    s_cbranch_scc1 L_end
    s_bfe_u32 s7, s2, 0x10002
    s_mul_i32 s4, s7, 48
    s_add_u32 s4, s0, s4
    s_addc_u32 s5, s1, 0
    s_load_dwordx8 s[8:15], s[4:5], 0
    s_load_dwordx4 s[16:19], s[4:5], 32
    s_load_dwordx4 s[72:75], s[0:1], 96
    s_load_dwordx2 s[44:45], s[0:1], 112
    v_lshrrev_b32 v1, 6, v0
    v_and_b32 v2, 63, v0
    v_readfirstlane_b32 s47, v1
    s_and_b32 s3, s2, 7
    s_lshr_b32 s6, s2, 3
    s_and_b32 s46, s2, 3
    s_mul_i32 s48, s46, 320
    s_and_b32 s43, s6, 7
    s_cmp_lg_u32 s43, s47
    s_cbranch_scc1 L_nopf
    s_getpc_b64 s[56:57]
L_pc:
    s_sub_u32 s56, s56, L_pc-concat_heads__ssm_conv_h3__ssm_conv_h3__prompt_kernel
    s_subb_u32 s57, s57, 0
    v_mul_u32_u24 v3, 44, v0
    v_min_u32 v3, L_end-concat_heads__ssm_conv_h3__ssm_conv_h3__prompt_kernel, v3
    global_load_dword v60, v3, s[56:57]
L_nopf:
    s_lshr_b32 s50, s47, 2
    s_lshl_b32 s50, s50, 7
    s_lshl_b32 s51, s6, 2
    s_add_u32 s50, s50, s51
    s_and_b32 s51, s47, 3
    s_add_u32 s50, s50, s51
    s_mul_i32 s52, s50, 10240
    s_add_u32 s52, s52, s48
    s_sub_u32 s53, s52, 5120
    s_mul_i32 s54, s47, 6400
    s_add_u32 s54, s54, 86784
    v_add_u32 v1, 0, v2
    v_mul_u32_u24 v3, 3277, v1
    v_lshrrev_b32 v3, 16, v3
    v_mul_u32_u24 v3, 960, v3
    v_lshl_add_u32 v48, v1, 4, v3
    v_add_u32 v52, s53, v48
    v_add_u32 v1, 64, v2
    v_mul_u32_u24 v3, 3277, v1
    v_lshrrev_b32 v3, 16, v3
    v_mul_u32_u24 v3, 960, v3
    v_lshl_add_u32 v49, v1, 4, v3
    v_add_u32 v53, s53, v49
    v_add_u32 v1, 128, v2
    v_mul_u32_u24 v3, 3277, v1
    v_lshrrev_b32 v3, 16, v3
    v_mul_u32_u24 v3, 960, v3
    v_lshl_add_u32 v50, v1, 4, v3
    v_add_u32 v54, s53, v50
    v_add_u32 v1, 192, v2
    v_mul_u32_u24 v3, 3277, v1
    v_lshrrev_b32 v3, 16, v3
    v_mul_u32_u24 v3, 960, v3
    v_lshl_add_u32 v51, v1, 4, v3
    v_add_u32 v55, s53, v51
    s_mov_b32 s22, 2621440
    s_mov_b32 s23, 0x20000
    s_mov_b32 s26, 2621440
    s_mov_b32 s27, 0x20000
    s_waitcnt lgkmcnt(0)
    s_mov_b32 s20, s10
    s_mov_b32 s21, s11
    s_mov_b32 s24, s12
    s_mov_b32 s25, s13
    s_cmp_ge_u32 s47, 4
    s_cbranch_scc1 L_bwave
    s_mov_b32 s32, s14
    s_mov_b32 s33, s15
    s_mov_b32 s34, 5120
    s_mov_b32 s35, 0x20000
    s_lshl_b32 s43, s48, 2
    v_lshl_add_u32 v1, v2, 3, s43
    buffer_load_dwordx2 v[216:217], v1, s[32:35], 0 offen offset:0
    buffer_load_dwordx2 v[218:219], v1, s[32:35], 0 offen offset:512
    v_and_b32 v1, 31, v2
    v_lshl_add_u32 v1, v1, 3, s43
    buffer_load_dwordx2 v[220:221], v1, s[32:35], 0 offen offset:1024
    s_add_u32 m0, s54, 0
    s_nop 0
    buffer_load_dwordx4 v52, s[20:23], 0 offen lds
    s_add_u32 m0, s54, 3840
    s_nop 0
    buffer_load_dwordx4 v48, s[24:27], s52 offen lds
    s_add_u32 m0, s54, 1024
    s_nop 0
    buffer_load_dwordx4 v53, s[20:23], 0 offen lds
    s_add_u32 m0, s54, 4864
    s_nop 0
    buffer_load_dwordx4 v49, s[24:27], s52 offen lds
    s_add_u32 m0, s54, 2048
    s_nop 0
    buffer_load_dwordx4 v54, s[20:23], 0 offen lds
    s_add_u32 m0, s54, 5888
    s_mov_b32 exec_hi, 0
    s_nop 0
    buffer_load_dwordx4 v50, s[24:27], s52 offen lds
    s_mov_b64 exec, -1
    s_add_u32 m0, s54, 3072
    s_mov_b32 exec_hi, 0xffff
    s_nop 0
    buffer_load_dwordx4 v55, s[20:23], 0 offen lds
    s_mov_b64 exec, -1
    s_lshl_b32 s55, s3, 7
    s_add_u32 s55, s55, 5308416
    s_load_dwordx2 s[58:59], s[44:45], s55
    s_sub_u32 s49, s6, 20
    s_lshl_b32 s49, s49, 1
    s_cmp_lt_u32 s6, 20
    s_cselect_b32 s49, s6, s49
    s_lshl_b32 s70, s49, 4
    s_add_u32 s70, s70, s48
    s_lshl_b32 s71, s47, 1
    s_add_u32 s78, s70, s71
    s_add_u32 s79, s78, 16
    s_min_u32 s78, s78, 1278
    s_min_u32 s79, s79, 1278
    s_and_b32 s76, s78, 0xffc
    s_and_b32 s77, s79, 0xffc
    s_lshl_b32 s78, s78, 11
    s_lshl_b32 s79, s79, 11
    s_load_dword s78, s[16:17], s78
    s_load_dword s79, s[16:17], s79
    s_load_dword s70, s[18:19], s76
    s_load_dword s71, s[18:19], s77
    s_barrier
    s_lshl_b32 s43, s3, 5
    s_lshl_b32 s55, s47, 3
    s_add_u32 s43, s43, s55
    s_lshl_b32 s43, s43, 7
    s_add_u32 s43, s43, 5242880
    v_bfe_u32 v1, v2, 2, 3
    v_lshl_add_u32 v249, v1, 7, s43
    v_and_b32 v1, 3, v2
    v_lshl_add_u32 v249, v1, 3, v249
    s_mul_i32 s43, s3, 20
    s_add_u32 s43, s43, s49
    s_lshl_b32 s43, s43, 15
    s_lshl_b32 s55, s47, 12
    s_add_u32 s43, s43, s55
    v_lshl_add_u32 v250, v2, 4, s43
    s_mov_b32 s36, s44
    s_mov_b32 s37, s45
    s_mov_b32 s38, 33554432
    s_mov_b32 s39, 0x20000
    v_mov_b32 v6, 0xffff0000
    v_bfe_u32 v1, v2, 2, 2
    v_mul_u32_u24 v222, 320, v1
    v_lshrrev_b32 v1, 4, v2
    v_lshl_add_u32 v222, v1, 5, v222
    v_and_b32 v1, 3, v2
    v_lshl_add_u32 v222, v1, 3, v222
    v_add_u32 v222, s54, v222
    s_mul_i32 s43, s3, 655360
    s_lshl_b32 s55, s50, 7
    s_add_u32 s43, s43, s55
    v_lshrrev_b32 v1, 3, v2
    v_lshlrev_b32 v223, 15, v1
    v_and_b32 v1, 7, v2
    v_lshl_add_u32 v223, v1, 4, v223
    v_add_u32 v223, s43, v223
    v_lshrrev_b32 v3, 5, v2
    v_mul_u32_u24 v116, 1216, v3
    v_add3_u32 v116, v116, v222, 64
    v_add_u32 v116, 192, v116
    v_mul_u32_u24 v117, 131064, v3
    v_sub_u32 v117, v223, v117
    v_add_u32 v117, 524288, v117
    s_lshl_b32 s43, s3, 5
    s_add_u32 s43, s43, s6
    s_lshl_b32 s43, s43, 7
    s_lshl_b32 s55, s47, 3
    s_add_u32 s43, s43, s55
    s_add_u32 s43, s43, 5242880
    v_mov_b32 v224, s43
    s_mov_b32 s42, 32768
    v_add_u32 v225, s42, v224
    s_waitcnt lgkmcnt(0)
    s_mul_i32 s60, s58, 0x9E3779B1
    s_add_u32 s60, s60, 0x7F4A7C15
    s_mul_i32 s61, s59, 0x85EBCA6B
    s_add_u32 s61, s61, s60
    v_mov_b32 v228, s60
    v_mov_b32 v229, s61
    s_waitcnt vmcnt(9)
    v_and_b32 v100, v6, v217
    v_bfi_b32 v101, v6, v216, v217
    v_and_b32 v102, 0xffff, v216
    v_alignbit_b32 v103, v217, v217, 16
    v_alignbit_b32 v104, v216, v216, 16
    s_waitcnt vmcnt(8)
    v_and_b32 v105, v6, v219
    v_bfi_b32 v106, v6, v218, v219
    v_and_b32 v107, 0xffff, v218
    v_alignbit_b32 v108, v219, v219, 16
    v_alignbit_b32 v109, v218, v218, 16
    s_waitcnt vmcnt(7)
    v_and_b32 v110, v6, v221
    v_bfi_b32 v111, v6, v220, v221
    v_and_b32 v112, 0xffff, v220
    v_alignbit_b32 v113, v221, v221, 16
    v_alignbit_b32 v114, v220, v220, 16
    s_waitcnt vmcnt(0)
    ds_read_b64_tr_b16 v[120:121], v222 offset:0
    ds_read_b64_tr_b16 v[122:123], v222 offset:1280
    ds_read_b64_tr_b16 v[124:125], v222 offset:2560
    ds_read_b64_tr_b16 v[126:127], v222 offset:3840
    ds_read_b64_tr_b16 v[128:129], v222 offset:5120
    ds_read_b64_tr_b16 v[130:131], v222 offset:128
    ds_read_b64_tr_b16 v[132:133], v222 offset:1408
    ds_read_b64_tr_b16 v[134:135], v222 offset:2688
    ds_read_b64_tr_b16 v[136:137], v222 offset:3968
    ds_read_b64_tr_b16 v[138:139], v222 offset:5248
    ds_read_b64_tr_b16 v[140:141], v116 offset:0
    ds_read_b64_tr_b16 v[142:143], v116 offset:1280
    ds_read_b64_tr_b16 v[146:147], v116 offset:3840
    s_waitcnt lgkmcnt(12)
    v_dot2_f32_bf16 v36, v120, v100, 0
    v_dot2_f32_bf16 v37, v121, v103, 0
    v_dot2_f32_bf16 v38, v121, v100, 0
    s_waitcnt lgkmcnt(11)
    v_dot2_f32_bf16 v39, v122, v103, 0
    v_dot2_f32_bf16 v40, v122, v100, 0
    v_dot2_f32_bf16 v41, v123, v103, 0
    v_dot2_f32_bf16 v42, v123, v100, 0
    s_waitcnt lgkmcnt(10)
    v_dot2_f32_bf16 v43, v124, v103, 0
    v_dot2_f32_bf16 v36, v121, v101, v36
    v_dot2_f32_bf16 v37, v122, v104, v37
    v_dot2_f32_bf16 v38, v122, v101, v38
    v_dot2_f32_bf16 v39, v123, v104, v39
    v_dot2_f32_bf16 v40, v123, v101, v40
    v_dot2_f32_bf16 v41, v124, v104, v41
    v_dot2_f32_bf16 v42, v124, v101, v42
    v_dot2_f32_bf16 v43, v125, v104, v43
    v_dot2_f32_bf16 v36, v122, v102, v36
    v_dot2_f32_bf16 v38, v123, v102, v38
    v_dot2_f32_bf16 v40, v124, v102, v40
    v_dot2_f32_bf16 v42, v125, v102, v42
    s_waitcnt lgkmcnt(9)
    v_lshlrev_b32 v150, 16, v126
    v_and_b32 v151, v6, v126
    v_lshlrev_b32 v152, 16, v127
    v_and_b32 v153, v6, v127
    s_waitcnt lgkmcnt(8)
    v_lshlrev_b32 v154, 16, v128
    v_and_b32 v155, v6, v128
    v_lshlrev_b32 v156, 16, v129
    v_and_b32 v157, v6, v129
    v_pk_mul_f32 v[36:37], v[36:37], v[150:151]
    v_pk_mul_f32 v[38:39], v[38:39], v[152:153]
    v_pk_mul_f32 v[40:41], v[40:41], v[154:155]
    v_pk_mul_f32 v[42:43], v[42:43], v[156:157]
    v_cvt_pk_bf16_f32 v232, v36, v37
    v_cvt_pk_bf16_f32 v233, v38, v39
    v_cvt_pk_bf16_f32 v234, v40, v41
    v_cvt_pk_bf16_f32 v235, v42, v43
    buffer_store_dwordx4 v[232:235], v223, s[36:39], 0 offen sc1
    s_waitcnt lgkmcnt(7)
    v_dot2_f32_bf16 v36, v130, v105, 0
    v_dot2_f32_bf16 v37, v131, v108, 0
    v_dot2_f32_bf16 v38, v131, v105, 0
    s_waitcnt lgkmcnt(6)
    v_dot2_f32_bf16 v39, v132, v108, 0
    v_dot2_f32_bf16 v40, v132, v105, 0
    v_dot2_f32_bf16 v41, v133, v108, 0
    v_dot2_f32_bf16 v42, v133, v105, 0
    s_waitcnt lgkmcnt(5)
    v_dot2_f32_bf16 v43, v134, v108, 0
    v_dot2_f32_bf16 v36, v131, v106, v36
    v_dot2_f32_bf16 v37, v132, v109, v37
    v_dot2_f32_bf16 v38, v132, v106, v38
    v_dot2_f32_bf16 v39, v133, v109, v39
    v_dot2_f32_bf16 v40, v133, v106, v40
    v_dot2_f32_bf16 v41, v134, v109, v41
    v_dot2_f32_bf16 v42, v134, v106, v42
    v_dot2_f32_bf16 v43, v135, v109, v43
    v_dot2_f32_bf16 v36, v132, v107, v36
    v_dot2_f32_bf16 v38, v133, v107, v38
    v_dot2_f32_bf16 v40, v134, v107, v40
    v_dot2_f32_bf16 v42, v135, v107, v42
    s_waitcnt lgkmcnt(4)
    v_lshlrev_b32 v150, 16, v136
    v_and_b32 v151, v6, v136
    v_lshlrev_b32 v152, 16, v137
    v_and_b32 v153, v6, v137
    s_waitcnt lgkmcnt(3)
    v_lshlrev_b32 v154, 16, v138
    v_and_b32 v155, v6, v138
    v_lshlrev_b32 v156, 16, v139
    v_and_b32 v157, v6, v139
    v_pk_mul_f32 v[36:37], v[36:37], v[150:151]
    v_pk_mul_f32 v[38:39], v[38:39], v[152:153]
    v_pk_mul_f32 v[40:41], v[40:41], v[154:155]
    v_pk_mul_f32 v[42:43], v[42:43], v[156:157]
    v_cvt_pk_bf16_f32 v236, v36, v37
    v_cvt_pk_bf16_f32 v237, v38, v39
    v_cvt_pk_bf16_f32 v238, v40, v41
    v_cvt_pk_bf16_f32 v239, v42, v43
    s_mov_b32 s43, 262144
    buffer_store_dwordx4 v[236:239], v223, s[36:39], s43 offen sc1
    s_waitcnt lgkmcnt(2)
    v_dot2_f32_bf16 v36, v140, v110, 0
    v_dot2_f32_bf16 v37, v141, v113, 0
    v_dot2_f32_bf16 v38, v141, v110, 0
    s_waitcnt lgkmcnt(1)
    v_dot2_f32_bf16 v39, v142, v113, 0
    v_dot2_f32_bf16 v36, v141, v111, v36
    v_dot2_f32_bf16 v37, v142, v114, v37
    v_dot2_f32_bf16 v38, v142, v111, v38
    v_dot2_f32_bf16 v39, v143, v114, v39
    v_dot2_f32_bf16 v36, v142, v112, v36
    v_dot2_f32_bf16 v38, v143, v112, v38
    s_waitcnt lgkmcnt(0)
    v_lshlrev_b32 v150, 16, v146
    v_and_b32 v151, v6, v146
    v_lshlrev_b32 v152, 16, v147
    v_and_b32 v153, v6, v147
    v_pk_mul_f32 v[36:37], v[36:37], v[150:151]
    v_pk_mul_f32 v[38:39], v[38:39], v[152:153]
    v_cvt_pk_bf16_f32 v240, v36, v37
    v_cvt_pk_bf16_f32 v241, v38, v39
    buffer_store_dwordx2 v[240:241], v117, s[36:39], 0 offen sc1
    s_waitcnt vmcnt(0)
    s_mov_b64 exec, 1
    buffer_store_dwordx2 v[228:229], v224, s[36:39], 0 offen
    s_mov_b64 exec, -1
    buffer_load_dwordx2 v[252:253], v249, s[36:39], 0 offen sc1
    s_mov_b64 exec, 1
    buffer_store_dwordx2 v[228:229], v225, s[36:39], 0 offen sc1
    s_mov_b64 exec, -1
    s_cmp_ge_u32 s6, 30
    s_cbranch_scc1 L_idle
    s_mov_b32 s65, 0
    s_waitcnt vmcnt(1)
    s_branch L_pchk_a
L_poll_a:
    s_sleep 1
    buffer_load_dwordx2 v[252:253], v249, s[36:39], 0 offen sc1
    s_waitcnt vmcnt(0)
L_pchk_a:
    v_cmp_ne_u64 vcc, s[60:61], v[252:253]
    s_add_u32 s65, s65, 1
    s_cmp_gt_u32 s65, 0x40000
    s_cbranch_scc1 L_pdone_a
    s_cmp_eq_u64 vcc, 0
    s_cbranch_scc1 L_pdone_a
    s_cmp_lt_u32 s65, 6
    s_cbranch_scc1 L_poll_a
    buffer_load_dwordx2 v[254:255], v249, s[36:39], s42 offen sc1
    s_waitcnt vmcnt(0)
    v_cmp_ne_u64 s[68:69], s[60:61], v[254:255]
    s_nop 1
    s_and_b64 vcc, vcc, s[68:69]
    s_cbranch_scc1 L_poll_a
L_pdone_a:
    s_cmp_ge_u32 s6, 20
    s_cbranch_scc1 L_xmid
    buffer_load_dwordx4 v[60:63], v250, s[36:39], 0 offen offset:0 sc1
    buffer_load_dwordx4 v[64:67], v250, s[36:39], 0 offen offset:1024 sc1
    buffer_load_dwordx4 v[68:71], v250, s[36:39], 0 offen offset:2048 sc1
    buffer_load_dwordx4 v[72:75], v250, s[36:39], 0 offen offset:3072 sc1
    v_and_b32 v1, 7, v2
    v_mul_u32_u24 v251, 4368, v1
    v_lshrrev_b32 v1, 3, v2
    v_lshl_add_u32 v251, v1, 4, v251
    s_lshl_b32 s43, s47, 9
    s_add_u32 s43, s43, 256
    v_add_u32 v251, s43, v251
    v_lshrrev_b32 v3, 4, v2
    v_bfe_u32 v14, v2, 2, 2
    v_and_b32 v15, 3, v2
    v_lshl_add_u32 v1, v3, 3, v14
    s_mul_i32 s66, s47, 4128
    s_add_u32 s66, s66, 34952
    v_add_u32 v44, v15, v1
    v_lshl_add_u32 v5, v44, 3, s66
    s_add_u32 s66, s66, 24
    v_mov_b32 v10, s66
    s_bitcmp1_b32 s47, 0
    s_cselect_b32 s67, 0, 16
    s_lshl_b32 s70, s70, s67
    s_and_b32 s70, s70, 0xffff0000
    v_mov_b32 v8, s70
    s_lshl_b32 s78, s78, 16
    v_add_f32 v8, s78, v8
    v_cvt_pk_bf16_f32 v8, v8, v8
    s_mul_i32 s66, s47, 4368
    s_add_u32 s66, s66, 248
    v_lshlrev_b32 v44, 2, v15
    v_sub_u32 v44, v44, v1
    v_lshl_add_u32 v4, v44, 3, s66
    s_mov_b32 s20, s8
    s_mov_b32 s21, s9
    s_mov_b32 s22, 2621440
    s_mov_b32 s23, 0x20000
    s_mov_b32 s28, s72
    s_mov_b32 s29, s73
    s_mov_b32 s30, 5242880
    s_mov_b32 s31, 0x20000
    s_mov_b32 s40, 0
    s_mov_b32 s41, 0x80000000
    v_and_b32 v45, 1, v3
    v_lshrrev_b32 v46, 1, v3
    v_lshlrev_b32 v1, 6, v15
    v_lshl_add_u32 v1, v45, 2, v1
    v_add_u32 v1, v1, v14
    s_lshl_b32 s66, s47, 3
    v_add_u32 v1, s66, v1
    v_mul_u32_u24 v1, 1280, v1
    v_lshl_add_u32 v12, v46, 3, v1
    v_add_u32 v9, v12, v1
    s_lshl_b32 s43, s49, 4
    s_add_u32 s66, s43, s48
    s_mul_i32 s67, s3, 320
    s_add_u32 s67, s67, s43
    s_add_u32 s50, s66, 0
    s_add_u32 s55, s67, 0
    s_add_u32 s51, s66, 327680
    s_add_u32 s56, s67, 655360
    s_add_u32 s52, s66, 1638400
    s_add_u32 s57, s67, 3276800
    s_add_u32 s53, s66, 1966080
    s_add_u32 s58, s67, 3932160
    s_add_u32 s54, s66, 2293760
    s_add_u32 s59, s67, 4587520
    s_mul_i32 s66, s47, 2624
    s_add_u32 s66, s66, 67968
    v_lshl_add_u32 v7, v2, 3, s66
    v_lshl_add_u32 v1, v46, 2, v14
    v_mul_u32_u24 v1, 2624, v1
    v_lshl_add_u32 v44, v45, 2, v15
    v_lshl_add_u32 v1, v44, 3, v1
    s_lshl_b32 s66, s47, 6
    s_add_u32 s66, s66, 67968
    v_add_u32 v13, s66, v1
    s_waitcnt vmcnt(3)
    ds_write_b128 v251, v[60:63] offset:0
    s_waitcnt vmcnt(2)
    ds_write_b128 v251, v[64:67] offset:128
    s_waitcnt vmcnt(1)
    ds_write_b128 v251, v[68:71] offset:256
    s_waitcnt vmcnt(0)
    ds_write_b128 v251, v[72:75] offset:384
    v_add_u32 v249, 32, v249
    s_waitcnt lgkmcnt(0)
    s_barrier
    s_mov_b64 exec, 1
    ds_write_b16 v10, v8
    s_mov_b64 exec, -1
    ds_read_b64_tr_b16 v[212:213], v5 offset:0
    ds_read_b64_tr_b16 v[214:215], v5 offset:32
    ds_read_b64_tr_b16 v[208:209], v5 offset:256
    ds_read_b64_tr_b16 v[210:211], v5 offset:288
    ds_read_b64_tr_b16 v[204:205], v5 offset:512
    ds_read_b64_tr_b16 v[206:207], v5 offset:544
    ds_read_b64_tr_b16 v[200:201], v5 offset:768
    ds_read_b64_tr_b16 v[202:203], v5 offset:800
    ds_read_b64_tr_b16 v[196:197], v5 offset:2560
    ds_read_b64_tr_b16 v[198:199], v5 offset:2592
    ds_read_b64_tr_b16 v[192:193], v5 offset:2816
    ds_read_b64_tr_b16 v[194:195], v5 offset:2848
    ds_read_b64_tr_b16 v[188:189], v5 offset:3072
    ds_read_b64_tr_b16 v[190:191], v5 offset:3104
    ds_read_b64_tr_b16 v[184:185], v5 offset:3328
    ds_read_b64_tr_b16 v[186:187], v5 offset:3360
    ds_read_b64_tr_b16 v[180:181], v5 offset:3584
    ds_read_b64_tr_b16 v[182:183], v5 offset:3616
    ds_read_b64_tr_b16 v[176:177], v5 offset:3840
    ds_read_b64_tr_b16 v[178:179], v5 offset:3872
    s_branch L_p2_big
L_xmid:
    buffer_load_dwordx4 v[60:63], v250, s[36:39], 0 offen offset:0 sc1
    buffer_load_dwordx4 v[64:67], v250, s[36:39], 0 offen offset:1024 sc1
    buffer_load_dwordx4 v[68:71], v250, s[36:39], 0 offen offset:2048 sc1
    buffer_load_dwordx4 v[72:75], v250, s[36:39], 0 offen offset:3072 sc1
    s_mov_b32 s43, 32768
    buffer_load_dwordx4 v[76:79], v250, s[36:39], s43 offen offset:0 sc1
    buffer_load_dwordx4 v[80:83], v250, s[36:39], s43 offen offset:1024 sc1
    buffer_load_dwordx4 v[84:87], v250, s[36:39], s43 offen offset:2048 sc1
    buffer_load_dwordx4 v[88:91], v250, s[36:39], s43 offen offset:3072 sc1
    v_and_b32 v1, 7, v2
    v_mul_u32_u24 v251, 2832, v1
    v_lshrrev_b32 v1, 3, v2
    v_lshl_add_u32 v251, v1, 4, v251
    s_lshl_b32 s43, s47, 9
    s_add_u32 s43, s43, 256
    v_add_u32 v251, s43, v251
    v_lshrrev_b32 v3, 4, v2
    v_bfe_u32 v14, v2, 2, 2
    v_and_b32 v15, 3, v2
    v_lshl_add_u32 v1, v3, 3, v14
    s_mul_i32 s66, s47, 2592
    s_add_u32 s66, s66, 45320
    v_add_u32 v44, v15, v1
    v_lshl_add_u32 v5, v44, 3, s66
    s_add_u32 s66, s66, 24
    v_mov_b32 v10, s66
    s_bitcmp1_b32 s47, 0
    s_cselect_b32 s67, 0, 16
    s_lshl_b32 s70, s70, s67
    s_and_b32 s70, s70, 0xffff0000
    v_mov_b32 v8, s70
    s_lshl_b32 s78, s78, 16
    v_add_f32 v8, s78, v8
    s_lshl_b32 s71, s71, s67
    s_and_b32 s71, s71, 0xffff0000
    v_mov_b32 v11, s71
    s_lshl_b32 s79, s79, 16
    v_add_f32 v11, s79, v11
    v_cvt_pk_bf16_f32 v8, v8, v11
    s_mul_i32 s66, s47, 2832
    s_add_u32 s66, s66, 248
    v_lshlrev_b32 v44, 2, v15
    v_sub_u32 v44, v44, v1
    v_lshl_add_u32 v4, v44, 3, s66
    s_mov_b32 s20, s8
    s_mov_b32 s21, s9
    s_mov_b32 s22, 2621440
    s_mov_b32 s23, 0x20000
    s_mov_b32 s28, s72
    s_mov_b32 s29, s73
    s_mov_b32 s30, 5242880
    s_mov_b32 s31, 0x20000
    s_mov_b32 s40, 0
    s_mov_b32 s41, 0x80000000
    v_and_b32 v45, 1, v3
    v_lshrrev_b32 v46, 1, v3
    v_lshlrev_b32 v1, 6, v15
    v_lshl_add_u32 v1, v45, 2, v1
    v_add_u32 v1, v1, v14
    s_lshl_b32 s66, s47, 3
    v_add_u32 v1, s66, v1
    v_mul_u32_u24 v1, 1280, v1
    v_lshl_add_u32 v12, v46, 4, v1
    v_add_u32 v9, v12, v1
    s_lshl_b32 s43, s49, 4
    s_add_u32 s66, s43, s48
    s_mul_i32 s67, s3, 320
    s_add_u32 s67, s67, s43
    s_add_u32 s50, s66, 655360
    s_add_u32 s55, s67, 1310720
    s_add_u32 s51, s66, 983040
    s_add_u32 s56, s67, 1966080
    s_add_u32 s52, s66, 1310720
    s_add_u32 s57, s67, 2621440
    s_mul_i32 s66, s47, 1600
    s_add_u32 s66, s66, 86784
    v_lshl_add_u32 v7, v2, 3, s66
    v_lshl_add_u32 v1, v46, 3, v14
    v_mul_u32_u24 v1, 1600, v1
    v_lshl_add_u32 v44, v45, 2, v15
    v_lshl_add_u32 v1, v44, 3, v1
    s_lshl_b32 s66, s47, 6
    s_add_u32 s66, s66, 86784
    v_add_u32 v13, s66, v1
    s_waitcnt vmcnt(7)
    ds_write_b128 v251, v[60:63] offset:0
    s_waitcnt vmcnt(6)
    ds_write_b128 v251, v[64:67] offset:128
    s_waitcnt vmcnt(5)
    ds_write_b128 v251, v[68:71] offset:256
    s_waitcnt vmcnt(4)
    ds_write_b128 v251, v[72:75] offset:384
    s_waitcnt vmcnt(3)
    ds_write_b128 v251, v[76:79] offset:22656
    s_waitcnt vmcnt(2)
    ds_write_b128 v251, v[80:83] offset:22784
    s_waitcnt vmcnt(1)
    ds_write_b128 v251, v[84:87] offset:22912
    s_waitcnt vmcnt(0)
    ds_write_b128 v251, v[88:91] offset:23040
    s_lshl_b32 s43, s3, 5
    s_lshl_b32 s66, s47, 1
    s_add_u32 s43, s43, s66
    s_lshl_b32 s43, s43, 7
    s_add_u32 s43, s43, 5242912
    v_bfe_u32 v1, v2, 2, 1
    v_lshl_add_u32 v249, v1, 7, s43
    v_lshl_add_u32 v249, v15, 3, v249
    s_mul_i32 s43, s47, 3072
    v_subrev_u32 v250, s43, v250
    s_mul_i32 s43, s47, 384
    v_subrev_u32 v251, s43, v251
    s_waitcnt lgkmcnt(0)
    s_barrier
    s_mov_b64 exec, 1
    ds_write_b16 v10, v8
    ds_write_b16_d16_hi v10, v8 offset:20736
    s_mov_b64 exec, -1
    ds_read_b64_tr_b16 v[212:213], v5 offset:1024
    ds_read_b64_tr_b16 v[214:215], v5 offset:1056
    ds_read_b64_tr_b16 v[208:209], v5 offset:1280
    ds_read_b64_tr_b16 v[210:211], v5 offset:1312
    ds_read_b64_tr_b16 v[204:205], v5 offset:1536
    ds_read_b64_tr_b16 v[206:207], v5 offset:1568
    ds_read_b64_tr_b16 v[200:201], v5 offset:1792
    ds_read_b64_tr_b16 v[202:203], v5 offset:1824
    ds_read_b64_tr_b16 v[196:197], v5 offset:2048
    ds_read_b64_tr_b16 v[198:199], v5 offset:2080
    ds_read_b64_tr_b16 v[192:193], v5 offset:2304
    ds_read_b64_tr_b16 v[194:195], v5 offset:2336
    ds_read_b64_tr_b16 v[188:189], v5 offset:768
    ds_read_b64_tr_b16 v[190:191], v5 offset:800
    ds_read_b64_tr_b16 v[184:185], v5 offset:512
    ds_read_b64_tr_b16 v[186:187], v5 offset:544
    ds_read_b64_tr_b16 v[180:181], v5 offset:256
    ds_read_b64_tr_b16 v[182:183], v5 offset:288
    ds_read_b64_tr_b16 v[176:177], v5 offset:0
    ds_read_b64_tr_b16 v[178:179], v5 offset:32
    s_branch L_p2_mid
L_idle:
    s_cmp_lg_u32 s6, 30
    s_cbranch_scc1 L_fin
    s_cmp_lg_u32 s47, 0
    s_cbranch_scc1 L_fin
    s_lshl_b32 s43, s3, 12
    s_add_u32 s43, s43, 5242880
    v_lshrrev_b32 v1, 3, v2
    v_lshl_add_u32 v249, v1, 7, s43
    v_and_b32 v1, 7, v2
    v_lshl_add_u32 v249, v1, 3, v249
    s_mov_b32 s66, 0
L_eloop:
    s_mov_b32 s65, 0
L_poll_e:
    s_sleep 4
    buffer_load_dwordx2 v[252:253], v249, s[36:39], 0 offen sc1
    s_waitcnt vmcnt(0)
L_pchk_e:
    v_cmp_ne_u64 vcc, s[60:61], v[252:253]
    s_add_u32 s65, s65, 1
    s_cmp_gt_u32 s65, 0x40000
    s_cbranch_scc1 L_pdone_e
    s_cmp_eq_u64 vcc, 0
    s_cbranch_scc1 L_pdone_e
    s_cmp_lt_u32 s65, 6
    s_cbranch_scc1 L_poll_e
    buffer_load_dwordx2 v[254:255], v249, s[36:39], s42 offen sc1
    s_waitcnt vmcnt(0)
    v_cmp_ne_u64 s[68:69], s[60:61], v[254:255]
    s_nop 1
    s_and_b64 vcc, vcc, s[68:69]
    s_cbranch_scc1 L_poll_e
L_pdone_e:
    v_add_u32 v249, 1024, v249
    s_add_u32 s66, s66, 1
    s_cmp_lt_u32 s66, 4
    s_cbranch_scc1 L_eloop
    s_lshl_b32 s43, s3, 7
    s_add_u32 s43, s43, 5308416
    v_mov_b32 v1, s43
    s_mov_b64 exec, 1
    buffer_store_dwordx2 v[228:229], v1, s[36:39], 0 offen sc1
    s_mov_b64 exec, -1
    s_branch L_fin
L_bwave:
    s_cmp_lg_u32 s47, 7
    s_cbranch_scc1 L_nopres
L_nopres:
    s_lshl_b32 s55, s3, 7
    s_add_u32 s55, s55, 5308416
    s_load_dwordx2 s[58:59], s[44:45], s55
    s_sub_u32 s49, s6, 20
    s_lshl_b32 s49, s49, 1
    s_cmp_lt_u32 s6, 20
    s_cselect_b32 s49, s6, s49
    s_lshl_b32 s70, s49, 4
    s_add_u32 s70, s70, s48
    s_lshl_b32 s71, s47, 1
    s_add_u32 s78, s70, s71
    s_add_u32 s79, s78, 16
    s_min_u32 s78, s78, 1278
    s_min_u32 s79, s79, 1278
    s_and_b32 s76, s78, 0xffc
    s_and_b32 s77, s79, 0xffc
    s_lshl_b32 s78, s78, 11
    s_lshl_b32 s79, s79, 11
    s_load_dword s78, s[16:17], s78
    s_load_dword s79, s[16:17], s79
    s_load_dword s70, s[18:19], s76
    s_load_dword s71, s[18:19], s77
    s_mov_b32 s32, s14
    s_mov_b32 s33, s15
    s_mov_b32 s34, 5120
    s_mov_b32 s35, 0x20000
    s_lshl_b32 s43, s48, 2
    v_lshl_add_u32 v1, v2, 3, s43
    buffer_load_dwordx2 v[216:217], v1, s[32:35], 0 offen offset:0
    buffer_load_dwordx2 v[218:219], v1, s[32:35], 0 offen offset:512
    v_and_b32 v1, 31, v2
    v_lshl_add_u32 v1, v1, 3, s43
    buffer_load_dwordx2 v[220:221], v1, s[32:35], 0 offen offset:1024
    s_mov_b32 s28, s16
    s_mov_b32 s29, s17
    s_mov_b32 s30, 2621440
    s_mov_b32 s31, 0x20000
    v_lshlrev_b32 v3, 4, v2
    v_mov_b32 v56, 0
    v_mov_b32 v57, 0
    v_mov_b32 v58, 0
    v_mov_b32 v59, 0
    v_mov_b32 v249, 0
    v_mov_b32 v250, 0
    s_cmp_ge_u32 s6, 30
    s_cbranch_scc1 L_bidle
    s_mul_i32 s66, s46, 160
    s_lshl_b32 s67, s49, 3
    s_add_u32 s66, s66, s67
    s_add_u32 s66, s66, s51
    s_lshl_b32 s66, s66, 12
    s_cmp_ge_u32 s6, 20
    s_cbranch_scc1 L_hmid
    v_lshrrev_b32 v4, 4, v2
    v_min_u32 v4, 1, v4
    v_mul_u32_u24 v4, 17472, v4
    v_and_b32 v5, 15, v2
    v_lshl_add_u32 v4, v5, 4, v4
    s_mul_i32 s67, s51, 4368
    v_add_u32 v4, s67, v4
    ds_write_b128 v4, v[56:59] offset:0
    v_lshrrev_b32 v4, 1, v2
    v_min_u32 v4, 1, v4
    v_mul_u32_u24 v4, 16512, v4
    v_and_b32 v5, 1, v2
    v_lshl_add_u32 v4, v5, 4, v4
    s_mul_i32 s67, s51, 4128
    v_add_u32 v4, s67, v4
    ds_write_b128 v4, v[56:59] offset:34944
    s_add_u32 s67, s67, 34976
    s_barrier
    s_mov_b32 m0, s67
    s_waitcnt vmcnt(7)
    buffer_load_dwordx4 v3, s[28:31], s66 offen offset:0 lds
    buffer_load_dwordx4 v3, s[28:31], s66 offen offset:1024 lds
    s_waitcnt vmcnt(7)
    buffer_load_dwordx4 v3, s[28:31], s66 offen offset:2048 lds
    buffer_load_dwordx4 v3, s[28:31], s66 offen offset:3072 lds
    s_add_u32 s67, s67, 16512
    s_add_u32 s66, s66, 16384
    s_mov_b32 m0, s67
    s_waitcnt vmcnt(7)
    buffer_load_dwordx4 v3, s[28:31], s66 offen offset:0 lds
    buffer_load_dwordx4 v3, s[28:31], s66 offen offset:1024 lds
    s_waitcnt vmcnt(7)
    buffer_load_dwordx4 v3, s[28:31], s66 offen offset:2048 lds
    buffer_load_dwordx4 v3, s[28:31], s66 offen offset:3072 lds
    s_add_u32 s67, s67, 16512
    s_add_u32 s66, s66, 16384
    s_waitcnt vmcnt(7)
    s_add_u32 m0, s54, 0
    s_nop 0
    buffer_load_dwordx4 v52, s[20:23], 0 offen lds
    s_add_u32 m0, s54, 3840
    s_nop 0
    buffer_load_dwordx4 v48, s[24:27], s52 offen lds
    s_waitcnt vmcnt(7)
    s_add_u32 m0, s54, 1024
    s_nop 0
    buffer_load_dwordx4 v53, s[20:23], 0 offen lds
    s_add_u32 m0, s54, 4864
    s_nop 0
    buffer_load_dwordx4 v49, s[24:27], s52 offen lds
    s_waitcnt vmcnt(7)
    s_add_u32 m0, s54, 2048
    s_nop 0
    buffer_load_dwordx4 v54, s[20:23], 0 offen lds
    s_add_u32 m0, s54, 5888
    s_mov_b32 exec_hi, 0
    s_nop 0
    buffer_load_dwordx4 v50, s[24:27], s52 offen lds
    s_mov_b64 exec, -1
    s_waitcnt vmcnt(7)
    s_add_u32 m0, s54, 3072
    s_mov_b32 exec_hi, 0xffff
    s_nop 0
    buffer_load_dwordx4 v55, s[20:23], 0 offen lds
    s_mov_b64 exec, -1
    s_waitcnt lgkmcnt(0)
    s_mov_b32 s36, s44
    s_mov_b32 s37, s45
    s_mov_b32 s38, 33554432
    s_mov_b32 s39, 0x20000
    v_mov_b32 v6, 0xffff0000
    v_bfe_u32 v1, v2, 2, 2
    v_mul_u32_u24 v222, 320, v1
    v_lshrrev_b32 v1, 4, v2
    v_lshl_add_u32 v222, v1, 5, v222
    v_and_b32 v1, 3, v2
    v_lshl_add_u32 v222, v1, 3, v222
    v_add_u32 v222, s54, v222
    s_mul_i32 s43, s3, 655360
    s_lshl_b32 s55, s50, 7
    s_add_u32 s43, s43, s55
    v_lshrrev_b32 v1, 3, v2
    v_lshlrev_b32 v223, 15, v1
    v_and_b32 v1, 7, v2
    v_lshl_add_u32 v223, v1, 4, v223
    v_add_u32 v223, s43, v223
    v_lshrrev_b32 v3, 5, v2
    v_mul_u32_u24 v116, 1216, v3
    v_add3_u32 v116, v116, v222, 64
    v_add_u32 v116, 192, v116
    v_mul_u32_u24 v117, 131064, v3
    v_sub_u32 v117, v223, v117
    v_add_u32 v117, 524288, v117
    s_lshl_b32 s43, s3, 5
    s_add_u32 s43, s43, s6
    s_lshl_b32 s43, s43, 7
    s_lshl_b32 s55, s47, 3
    s_add_u32 s43, s43, s55
    s_add_u32 s43, s43, 5242880
    v_mov_b32 v224, s43
    s_mov_b32 s42, 32768
    v_add_u32 v225, s42, v224
    s_mul_i32 s60, s58, 0x9E3779B1
    s_add_u32 s60, s60, 0x7F4A7C15
    s_mul_i32 s61, s59, 0x85EBCA6B
    s_add_u32 s61, s61, s60
    v_mov_b32 v228, s60
    v_mov_b32 v229, s61
    v_and_b32 v100, v6, v217
    v_bfi_b32 v101, v6, v216, v217
    v_and_b32 v102, 0xffff, v216
    v_alignbit_b32 v103, v217, v217, 16
    v_alignbit_b32 v104, v216, v216, 16
    v_and_b32 v105, v6, v219
    v_bfi_b32 v106, v6, v218, v219
    v_and_b32 v107, 0xffff, v218
    v_alignbit_b32 v108, v219, v219, 16
    v_alignbit_b32 v109, v218, v218, 16
    v_and_b32 v110, v6, v221
    v_bfi_b32 v111, v6, v220, v221
    v_and_b32 v112, 0xffff, v220
    v_alignbit_b32 v113, v221, v221, 16
    v_alignbit_b32 v114, v220, v220, 16
    v_lshrrev_b32 v3, 4, v2
    v_bfe_u32 v14, v2, 2, 2
    v_and_b32 v15, 3, v2
    v_lshl_add_u32 v1, v3, 3, v14
    s_mul_i32 s66, s47, 4128
    s_add_u32 s66, s66, 34952
    v_add_u32 v44, v15, v1
    v_lshl_add_u32 v5, v44, 3, s66
    s_add_u32 s66, s66, 24
    v_mov_b32 v10, s66
    s_bitcmp1_b32 s47, 0
    s_cselect_b32 s67, 0, 16
    s_lshl_b32 s70, s70, s67
    s_and_b32 s70, s70, 0xffff0000
    v_mov_b32 v8, s70
    s_lshl_b32 s78, s78, 16
    v_add_f32 v8, s78, v8
    v_cvt_pk_bf16_f32 v8, v8, v8
    s_mul_i32 s66, s47, 4368
    s_add_u32 s66, s66, 248
    v_lshlrev_b32 v44, 2, v15
    v_sub_u32 v44, v44, v1
    v_lshl_add_u32 v4, v44, 3, s66
    s_mov_b32 s20, s8
    s_mov_b32 s21, s9
    s_mov_b32 s22, 2621440
    s_mov_b32 s23, 0x20000
    s_mov_b32 s28, s72
    s_mov_b32 s29, s73
    s_mov_b32 s30, 5242880
    s_mov_b32 s31, 0x20000
    s_mov_b32 s40, 0
    s_mov_b32 s41, 0x80000000
    v_and_b32 v45, 1, v3
    v_lshrrev_b32 v46, 1, v3
    v_lshlrev_b32 v1, 6, v15
    v_lshl_add_u32 v1, v45, 2, v1
    v_add_u32 v1, v1, v14
    s_lshl_b32 s66, s47, 3
    v_add_u32 v1, s66, v1
    v_mul_u32_u24 v1, 1280, v1
    v_lshl_add_u32 v12, v46, 3, v1
    v_add_u32 v9, v12, v1
    s_lshl_b32 s43, s49, 4
    s_add_u32 s66, s43, s48
    s_mul_i32 s67, s3, 320
    s_add_u32 s67, s67, s43
    s_add_u32 s50, s66, 0
    s_add_u32 s55, s67, 0
    s_add_u32 s51, s66, 327680
    s_add_u32 s56, s67, 655360
    s_add_u32 s52, s66, 1638400
    s_add_u32 s57, s67, 3276800
    s_add_u32 s53, s66, 1966080
    s_add_u32 s58, s67, 3932160
    s_add_u32 s54, s66, 2293760
    s_add_u32 s59, s67, 4587520
    s_mul_i32 s66, s47, 2624
    s_add_u32 s66, s66, 67968
    v_lshl_add_u32 v7, v2, 3, s66
    v_lshl_add_u32 v1, v46, 2, v14
    v_mul_u32_u24 v1, 2624, v1
    v_lshl_add_u32 v44, v45, 2, v15
    v_lshl_add_u32 v1, v44, 3, v1
    s_lshl_b32 s66, s47, 6
    s_add_u32 s66, s66, 67968
    v_add_u32 v13, s66, v1
    s_waitcnt vmcnt(0)
    ds_read_b64_tr_b16 v[120:121], v222 offset:0
    ds_read_b64_tr_b16 v[122:123], v222 offset:1280
    ds_read_b64_tr_b16 v[124:125], v222 offset:2560
    ds_read_b64_tr_b16 v[126:127], v222 offset:3840
    ds_read_b64_tr_b16 v[128:129], v222 offset:5120
    ds_read_b64_tr_b16 v[130:131], v222 offset:128
    ds_read_b64_tr_b16 v[132:133], v222 offset:1408
    ds_read_b64_tr_b16 v[134:135], v222 offset:2688
    ds_read_b64_tr_b16 v[136:137], v222 offset:3968
    ds_read_b64_tr_b16 v[138:139], v222 offset:5248
    ds_read_b64_tr_b16 v[140:141], v116 offset:0
    ds_read_b64_tr_b16 v[142:143], v116 offset:1280
    ds_read_b64_tr_b16 v[146:147], v116 offset:3840
    s_waitcnt lgkmcnt(12)
    v_dot2_f32_bf16 v36, v120, v100, 0
    v_dot2_f32_bf16 v37, v121, v103, 0
    v_dot2_f32_bf16 v38, v121, v100, 0
    s_waitcnt lgkmcnt(11)
    v_dot2_f32_bf16 v39, v122, v103, 0
    v_dot2_f32_bf16 v40, v122, v100, 0
    v_dot2_f32_bf16 v41, v123, v103, 0
    v_dot2_f32_bf16 v42, v123, v100, 0
    s_waitcnt lgkmcnt(10)
    v_dot2_f32_bf16 v43, v124, v103, 0
    v_dot2_f32_bf16 v36, v121, v101, v36
    v_dot2_f32_bf16 v37, v122, v104, v37
    v_dot2_f32_bf16 v38, v122, v101, v38
    v_dot2_f32_bf16 v39, v123, v104, v39
    v_dot2_f32_bf16 v40, v123, v101, v40
    v_dot2_f32_bf16 v41, v124, v104, v41
    v_dot2_f32_bf16 v42, v124, v101, v42
    v_dot2_f32_bf16 v43, v125, v104, v43
    v_dot2_f32_bf16 v36, v122, v102, v36
    v_dot2_f32_bf16 v38, v123, v102, v38
    v_dot2_f32_bf16 v40, v124, v102, v40
    v_dot2_f32_bf16 v42, v125, v102, v42
    s_waitcnt lgkmcnt(9)
    v_lshlrev_b32 v150, 16, v126
    v_and_b32 v151, v6, v126
    v_lshlrev_b32 v152, 16, v127
    v_and_b32 v153, v6, v127
    s_waitcnt lgkmcnt(8)
    v_lshlrev_b32 v154, 16, v128
    v_and_b32 v155, v6, v128
    v_lshlrev_b32 v156, 16, v129
    v_and_b32 v157, v6, v129
    v_pk_mul_f32 v[36:37], v[36:37], v[150:151]
    v_pk_mul_f32 v[38:39], v[38:39], v[152:153]
    v_pk_mul_f32 v[40:41], v[40:41], v[154:155]
    v_pk_mul_f32 v[42:43], v[42:43], v[156:157]
    v_cvt_pk_bf16_f32 v232, v36, v37
    v_cvt_pk_bf16_f32 v233, v38, v39
    v_cvt_pk_bf16_f32 v234, v40, v41
    v_cvt_pk_bf16_f32 v235, v42, v43
    buffer_store_dwordx4 v[232:235], v223, s[36:39], 0 offen sc1
    s_waitcnt lgkmcnt(7)
    v_dot2_f32_bf16 v36, v130, v105, 0
    v_dot2_f32_bf16 v37, v131, v108, 0
    v_dot2_f32_bf16 v38, v131, v105, 0
    s_waitcnt lgkmcnt(6)
    v_dot2_f32_bf16 v39, v132, v108, 0
    v_dot2_f32_bf16 v40, v132, v105, 0
    v_dot2_f32_bf16 v41, v133, v108, 0
    v_dot2_f32_bf16 v42, v133, v105, 0
    s_waitcnt lgkmcnt(5)
    v_dot2_f32_bf16 v43, v134, v108, 0
    v_dot2_f32_bf16 v36, v131, v106, v36
    v_dot2_f32_bf16 v37, v132, v109, v37
    v_dot2_f32_bf16 v38, v132, v106, v38
    v_dot2_f32_bf16 v39, v133, v109, v39
    v_dot2_f32_bf16 v40, v133, v106, v40
    v_dot2_f32_bf16 v41, v134, v109, v41
    v_dot2_f32_bf16 v42, v134, v106, v42
    v_dot2_f32_bf16 v43, v135, v109, v43
    v_dot2_f32_bf16 v36, v132, v107, v36
    v_dot2_f32_bf16 v38, v133, v107, v38
    v_dot2_f32_bf16 v40, v134, v107, v40
    v_dot2_f32_bf16 v42, v135, v107, v42
    s_waitcnt lgkmcnt(4)
    v_lshlrev_b32 v150, 16, v136
    v_and_b32 v151, v6, v136
    v_lshlrev_b32 v152, 16, v137
    v_and_b32 v153, v6, v137
    s_waitcnt lgkmcnt(3)
    v_lshlrev_b32 v154, 16, v138
    v_and_b32 v155, v6, v138
    v_lshlrev_b32 v156, 16, v139
    v_and_b32 v157, v6, v139
    v_pk_mul_f32 v[36:37], v[36:37], v[150:151]
    v_pk_mul_f32 v[38:39], v[38:39], v[152:153]
    v_pk_mul_f32 v[40:41], v[40:41], v[154:155]
    v_pk_mul_f32 v[42:43], v[42:43], v[156:157]
    v_cvt_pk_bf16_f32 v236, v36, v37
    v_cvt_pk_bf16_f32 v237, v38, v39
    v_cvt_pk_bf16_f32 v238, v40, v41
    v_cvt_pk_bf16_f32 v239, v42, v43
    s_mov_b32 s43, 262144
    buffer_store_dwordx4 v[236:239], v223, s[36:39], s43 offen sc1
    s_waitcnt lgkmcnt(2)
    v_dot2_f32_bf16 v36, v140, v110, 0
    v_dot2_f32_bf16 v37, v141, v113, 0
    v_dot2_f32_bf16 v38, v141, v110, 0
    s_waitcnt lgkmcnt(1)
    v_dot2_f32_bf16 v39, v142, v113, 0
    v_dot2_f32_bf16 v36, v141, v111, v36
    v_dot2_f32_bf16 v37, v142, v114, v37
    v_dot2_f32_bf16 v38, v142, v111, v38
    v_dot2_f32_bf16 v39, v143, v114, v39
    v_dot2_f32_bf16 v36, v142, v112, v36
    v_dot2_f32_bf16 v38, v143, v112, v38
    s_waitcnt lgkmcnt(0)
    v_lshlrev_b32 v150, 16, v146
    v_and_b32 v151, v6, v146
    v_lshlrev_b32 v152, 16, v147
    v_and_b32 v153, v6, v147
    v_pk_mul_f32 v[36:37], v[36:37], v[150:151]
    v_pk_mul_f32 v[38:39], v[38:39], v[152:153]
    v_cvt_pk_bf16_f32 v240, v36, v37
    v_cvt_pk_bf16_f32 v241, v38, v39
    buffer_store_dwordx2 v[240:241], v117, s[36:39], 0 offen sc1
    s_mov_b64 exec, 1
    ds_write_b16 v10, v8
    s_mov_b64 exec, -1
    ds_read_b64_tr_b16 v[212:213], v5 offset:0
    ds_read_b64_tr_b16 v[214:215], v5 offset:32
    ds_read_b64_tr_b16 v[208:209], v5 offset:256
    ds_read_b64_tr_b16 v[210:211], v5 offset:288
    ds_read_b64_tr_b16 v[204:205], v5 offset:512
    ds_read_b64_tr_b16 v[206:207], v5 offset:544
    ds_read_b64_tr_b16 v[200:201], v5 offset:768
    ds_read_b64_tr_b16 v[202:203], v5 offset:800
    ds_read_b64_tr_b16 v[196:197], v5 offset:2560
    ds_read_b64_tr_b16 v[198:199], v5 offset:2592
    ds_read_b64_tr_b16 v[192:193], v5 offset:2816
    ds_read_b64_tr_b16 v[194:195], v5 offset:2848
    ds_read_b64_tr_b16 v[188:189], v5 offset:3072
    ds_read_b64_tr_b16 v[190:191], v5 offset:3104
    ds_read_b64_tr_b16 v[184:185], v5 offset:3328
    ds_read_b64_tr_b16 v[186:187], v5 offset:3360
    ds_read_b64_tr_b16 v[180:181], v5 offset:3584
    ds_read_b64_tr_b16 v[182:183], v5 offset:3616
    ds_read_b64_tr_b16 v[176:177], v5 offset:3840
    ds_read_b64_tr_b16 v[178:179], v5 offset:3872
    s_waitcnt lgkmcnt(0)
    s_barrier
    s_waitcnt vmcnt(0)
    s_mov_b64 exec, 1
    buffer_store_dwordx2 v[228:229], v224, s[36:39], 0 offen
    s_mov_b64 exec, -1
    v_lshrrev_b32 v1, 2, v2
    v_mul_u32_u24 v1, 1280, v1
    v_and_b32 v14, 3, v2
    v_lshlrev_b32 v14, 7, v14
    v_min_u32 v14, 316, v14
    v_add_u32 v1, v1, v14
    s_lshl_b32 s43, s6, 2
    s_and_b32 s66, s47, 3
    s_add_u32 s43, s43, s66
    s_mul_i32 s43, s43, 20480
    s_add_u32 s43, s43, s48
    buffer_load_dword v14, v1, s[20:23], s43 offen
    s_mov_b64 exec, 1
    buffer_store_dwordx2 v[228:229], v225, s[36:39], 0 offen sc1
    s_mov_b64 exec, -1
L_p2_big:
    s_setprio 3
    ds_read_b64_tr_b16 v[48:49], v4 offset:32
    ds_read_b64_tr_b16 v[50:51], v4 offset:0
    s_waitcnt lgkmcnt(0)
    v_mfma_f32_16x16x32_bf16 v[44:47], v[48:51], v[212:215], 0
    ds_read_b64_tr_b16 v[52:53], v4 offset:160
    ds_read_b64_tr_b16 v[54:55], v4 offset:128
    v_mfma_f32_16x16x32_bf16 v[56:59], v[48:51], v[208:211], 0
    ds_read_b64_tr_b16 v[64:65], v5 offset:2304
    ds_read_b64_tr_b16 v[66:67], v5 offset:2336
    v_mfma_f32_16x16x32_bf16 v[60:63], v[48:51], v[204:207], 0
    ds_read_b64_tr_b16 v[72:73], v4 offset:288
    ds_read_b64_tr_b16 v[74:75], v4 offset:256
    v_mfma_f32_16x16x32_bf16 v[68:71], v[48:51], v[200:203], 0
    v_add_f32_dpp v46, v47, v46 wave_shr:1 row_mask:0xf bank_mask:0xf bound_ctrl:0
    v_mfma_f32_16x16x32_bf16 v[76:79], v[48:51], v[196:199], 0
    s_nop 0
    v_add_f32_dpp v45, v46, v45 wave_shr:1 row_mask:0xf bank_mask:0xf bound_ctrl:0
    v_mfma_f32_16x16x32_bf16 v[80:83], v[48:51], v[192:195], 0
    ds_read_b64_tr_b16 v[88:89], v4 offset:416
    v_add_f32_dpp v44, v45, v44 wave_shr:1 row_mask:0xf bank_mask:0xf bound_ctrl:0
    v_mfma_f32_16x16x32_bf16 v[84:87], v[48:51], v[188:191], 0
    ds_read_b64_tr_b16 v[90:91], v4 offset:384
    v_mfma_f32_16x16x32_bf16 v[92:95], v[48:51], v[184:187], 0
    v_mfma_f32_16x16x32_bf16 v[96:99], v[48:51], v[180:183], 0
    ds_read_b64_tr_b16 v[104:105], v5 offset:2048
    ds_read_b64_tr_b16 v[106:107], v5 offset:2080
    v_mfma_f32_16x16x32_bf16 v[100:103], v[48:51], v[176:179], 0
    s_waitcnt lgkmcnt(4)
    v_mfma_f32_16x16x32_bf16 v[108:111], v[52:55], v[212:215], 0
    v_mfma_f32_16x16x32_bf16 v[112:115], v[52:55], v[208:211], 0
    v_mfma_f32_16x16x32_bf16 v[116:119], v[52:55], v[204:207], 0
    v_mfma_f32_16x16x32_bf16 v[120:123], v[52:55], v[200:203], 0
    v_mfma_f32_16x16x32_bf16 v[124:127], v[52:55], v[64:67], 0
    v_mfma_f32_16x16x32_bf16 v[128:131], v[52:55], v[196:199], 0
    ds_read_b64_tr_b16 v[136:137], v4 offset:544
    ds_read_b64_tr_b16 v[138:139], v4 offset:512
    v_mfma_f32_16x16x32_bf16 v[132:135], v[52:55], v[192:195], 0
    v_cndmask_b32 v47, v111, v47, s[40:41]
    v_mfma_f32_16x16x32_bf16 v[140:143], v[52:55], v[188:191], 0
    s_nop 0
    v_add_f32_dpp v110, v47, v110 wave_ror:1 row_mask:0xf bank_mask:0xf
    v_cndmask_b32 v46, v110, v46, s[40:41]
    v_mfma_f32_16x16x32_bf16 v[144:147], v[52:55], v[184:187], 0
    s_nop 0
    v_add_f32_dpp v109, v46, v109 wave_ror:1 row_mask:0xf bank_mask:0xf
    v_cndmask_b32 v45, v109, v45, s[40:41]
    v_mfma_f32_16x16x32_bf16 v[148:151], v[52:55], v[180:183], 0
    s_nop 0
    v_add_f32_dpp v108, v45, v108 wave_ror:1 row_mask:0xf bank_mask:0xf
    v_cvt_pk_bf16_f32 v46, v44, v108
    v_mfma_f32_16x16x32_bf16 v[152:155], v[52:55], v[176:179], 0
    v_mfma_f32_16x16x32_bf16 v[56:59], v[72:75], v[212:215], v[56:59]
    v_mfma_f32_16x16x32_bf16 v[60:63], v[72:75], v[208:211], v[60:63]
    s_setprio 2
    v_mfma_f32_16x16x32_bf16 v[68:71], v[72:75], v[204:207], v[68:71]
    ds_read_b64_tr_b16 v[156:157], v4 offset:672
    ds_read_b64_tr_b16 v[158:159], v4 offset:640
    v_mfma_f32_16x16x32_bf16 v[76:79], v[72:75], v[64:67], v[76:79]
    v_mfma_f32_16x16x32_bf16 v[80:83], v[72:75], v[196:199], v[80:83]
    ds_read_b64_tr_b16 v[160:161], v5 offset:1792
    v_cndmask_b32 v111, v59, v111, s[40:41]
    v_mfma_f32_16x16x32_bf16 v[84:87], v[72:75], v[192:195], v[84:87]
    ds_read_b64_tr_b16 v[162:163], v5 offset:1824
    v_add_f32_dpp v58, v111, v58 wave_ror:1 row_mask:0xf bank_mask:0xf
    v_mfma_f32_16x16x32_bf16 v[92:95], v[72:75], v[188:191], v[92:95]
    v_cndmask_b32 v110, v58, v110, s[40:41]
    v_mfma_f32_16x16x32_bf16 v[96:99], v[72:75], v[184:187], v[96:99]
    s_nop 0
    v_add_f32_dpp v57, v110, v57 wave_ror:1 row_mask:0xf bank_mask:0xf
    v_cndmask_b32 v109, v57, v109, s[40:41]
    v_mfma_f32_16x16x32_bf16 v[100:103], v[72:75], v[180:183], v[100:103]
    s_waitcnt lgkmcnt(2)
    v_add_f32_dpp v56, v109, v56 wave_ror:1 row_mask:0xf bank_mask:0xf
    v_mfma_f32_16x16x32_bf16 v[112:115], v[88:91], v[212:215], v[112:115]
    v_mfma_f32_16x16x32_bf16 v[116:119], v[88:91], v[208:211], v[116:119]
    v_mfma_f32_16x16x32_bf16 v[120:123], v[88:91], v[204:207], v[120:123]
    ds_read_b64_tr_b16 v[164:165], v4 offset:800
    ds_read_b64_tr_b16 v[166:167], v4 offset:768
    v_mfma_f32_16x16x32_bf16 v[124:127], v[88:91], v[104:107], v[124:127]
    v_mfma_f32_16x16x32_bf16 v[128:131], v[88:91], v[64:67], v[128:131]
    v_mfma_f32_16x16x32_bf16 v[132:135], v[88:91], v[196:199], v[132:135]
    s_nop 0
    v_cndmask_b32 v59, v115, v59, s[40:41]
    v_mfma_f32_16x16x32_bf16 v[140:143], v[88:91], v[192:195], v[140:143]
    s_nop 0
    v_add_f32_dpp v114, v59, v114 wave_ror:1 row_mask:0xf bank_mask:0xf
    v_cndmask_b32 v58, v114, v58, s[40:41]
    v_mfma_f32_16x16x32_bf16 v[144:147], v[88:91], v[188:191], v[144:147]
    s_cmp_lt_u32 s47, 4
    s_cbranch_scc0 L_hp_big
    buffer_load_dwordx2 v[252:253], v249, s[36:39], 0 offen sc1
    s_nop 1
L_hp_big:
    v_add_f32_dpp v113, v58, v113 wave_ror:1 row_mask:0xf bank_mask:0xf
    v_cndmask_b32 v57, v113, v57, s[40:41]
    v_mfma_f32_16x16x32_bf16 v[148:151], v[88:91], v[184:187], v[148:151]
    s_nop 0
    v_add_f32_dpp v112, v57, v112 wave_ror:1 row_mask:0xf bank_mask:0xf
    v_cvt_pk_bf16_f32 v47, v56, v112
    v_mfma_f32_16x16x32_bf16 v[152:155], v[88:91], v[180:183], v[152:155]
    ds_read_b64_tr_b16 v[168:169], v4 offset:928
    ds_write_b64 v7, v[46:47] offset:0
    v_mfma_f32_16x16x32_bf16 v[60:63], v[136:139], v[212:215], v[60:63]
    ds_read_b64_tr_b16 v[170:171], v4 offset:896
    ds_read_b64_tr_b16 v[172:173], v5 offset:1536
    v_mfma_f32_16x16x32_bf16 v[68:71], v[136:139], v[208:211], v[68:71]
    ds_read_b64_tr_b16 v[174:175], v5 offset:1568
    v_mfma_f32_16x16x32_bf16 v[76:79], v[136:139], v[104:107], v[76:79]
    v_mfma_f32_16x16x32_bf16 v[80:83], v[136:139], v[64:67], v[80:83]
    v_mfma_f32_16x16x32_bf16 v[84:87], v[136:139], v[196:199], v[84:87]
    s_nop 0
    v_cndmask_b32 v115, v63, v115, s[40:41]
    v_mfma_f32_16x16x32_bf16 v[92:95], v[136:139], v[192:195], v[92:95]
    s_setprio 1
    v_add_f32_dpp v62, v115, v62 wave_ror:1 row_mask:0xf bank_mask:0xf
    v_cndmask_b32 v114, v62, v114, s[40:41]
    v_mfma_f32_16x16x32_bf16 v[96:99], v[136:139], v[188:191], v[96:99]
    s_nop 0
    v_add_f32_dpp v61, v114, v61 wave_ror:1 row_mask:0xf bank_mask:0xf
    v_cndmask_b32 v113, v61, v113, s[40:41]
    v_mfma_f32_16x16x32_bf16 v[100:103], v[136:139], v[184:187], v[100:103]
    ds_read_b64_tr_b16 v[48:49], v4 offset:1056
    v_add_f32_dpp v60, v113, v60 wave_ror:1 row_mask:0xf bank_mask:0xf
    v_mfma_f32_16x16x32_bf16 v[116:119], v[156:159], v[212:215], v[116:119]
    ds_read_b64_tr_b16 v[50:51], v4 offset:1024
    v_mfma_f32_16x16x32_bf16 v[120:123], v[156:159], v[208:211], v[120:123]
    s_waitcnt lgkmcnt(2)
    v_mfma_f32_16x16x32_bf16 v[124:127], v[156:159], v[160:163], v[124:127]
    v_mfma_f32_16x16x32_bf16 v[128:131], v[156:159], v[104:107], v[128:131]
    v_mfma_f32_16x16x32_bf16 v[132:135], v[156:159], v[64:67], v[132:135]
    v_mfma_f32_16x16x32_bf16 v[140:143], v[156:159], v[196:199], v[140:143]
    ds_read_b64_tr_b16 v[52:53], v4 offset:1184
    v_cndmask_b32 v63, v119, v63, s[40:41]
    v_mfma_f32_16x16x32_bf16 v[144:147], v[156:159], v[192:195], v[144:147]
    ds_read_b64_tr_b16 v[54:55], v4 offset:1152
    v_add_f32_dpp v118, v63, v118 wave_ror:1 row_mask:0xf bank_mask:0xf
    v_mfma_f32_16x16x32_bf16 v[148:151], v[156:159], v[188:191], v[148:151]
    s_cmp_lt_u32 s47, 4
    s_cbranch_scc0 L_hl_big
    s_mov_b32 s65, 0
    s_waitcnt vmcnt(0)
    s_branch L_pchk_bbig
L_poll_bbig:
    s_sleep 1
    buffer_load_dwordx2 v[252:253], v249, s[36:39], 0 offen sc1
    s_waitcnt vmcnt(0)
L_pchk_bbig:
    v_cmp_ne_u64 vcc, s[60:61], v[252:253]
    s_add_u32 s65, s65, 1
    s_cmp_gt_u32 s65, 0x40000
    s_cbranch_scc1 L_pdone_bbig
    s_cmp_eq_u64 vcc, 0
    s_cbranch_scc1 L_pdone_bbig
    s_cmp_lt_u32 s65, 6
    s_cbranch_scc1 L_poll_bbig
    buffer_load_dwordx2 v[254:255], v249, s[36:39], s42 offen sc1
    s_waitcnt vmcnt(0)
    v_cmp_ne_u64 s[68:69], s[60:61], v[254:255]
    s_nop 1
    s_and_b64 vcc, vcc, s[68:69]
    s_cbranch_scc1 L_poll_bbig
L_pdone_bbig:
    s_mov_b32 s43, 16384
    buffer_load_dwordx4 v[232:235], v250, s[36:39], s43 offen sc1
    s_mov_b32 s43, 17408
    buffer_load_dwordx4 v[236:239], v250, s[36:39], s43 offen sc1
    s_mov_b32 s43, 18432
    buffer_load_dwordx4 v[240:243], v250, s[36:39], s43 offen sc1
    s_mov_b32 s43, 19456
    buffer_load_dwordx4 v[244:247], v250, s[36:39], s43 offen sc1
    s_nop 1
L_hl_big:
    ds_read_b64_tr_b16 v[176:177], v5 offset:1280
    v_cndmask_b32 v62, v118, v62, s[40:41]
    v_mfma_f32_16x16x32_bf16 v[152:155], v[156:159], v[184:187], v[152:155]
    ds_read_b64_tr_b16 v[178:179], v5 offset:1312
    v_add_f32_dpp v117, v62, v117 wave_ror:1 row_mask:0xf bank_mask:0xf
    v_mfma_f32_16x16x32_bf16 v[68:71], v[164:167], v[212:215], v[68:71]
    buffer_load_dwordx2 v[32:33], v12, s[20:23], s50 offen nt
    v_cndmask_b32 v61, v117, v61, s[40:41]
    v_mfma_f32_16x16x32_bf16 v[76:79], v[164:167], v[160:163], v[76:79]
    s_nop 0
    v_add_f32_dpp v116, v61, v116 wave_ror:1 row_mask:0xf bank_mask:0xf
    v_cvt_pk_bf16_f32 v62, v60, v116
    v_mfma_f32_16x16x32_bf16 v[80:83], v[164:167], v[104:107], v[80:83]
    s_nop 0
    v_cndmask_b32 v119, v71, v119, s[40:41]
    v_mfma_f32_16x16x32_bf16 v[84:87], v[164:167], v[64:67], v[84:87]
    ds_read_b64_tr_b16 v[72:73], v4 offset:1312
    v_add_f32_dpp v70, v119, v70 wave_ror:1 row_mask:0xf bank_mask:0xf
    v_mfma_f32_16x16x32_bf16 v[92:95], v[164:167], v[196:199], v[92:95]
    ds_read_b64_tr_b16 v[74:75], v4 offset:1280
    v_cndmask_b32 v118, v70, v118, s[40:41]
    v_mfma_f32_16x16x32_bf16 v[96:99], v[164:167], v[192:195], v[96:99]
    s_nop 0
    v_add_f32_dpp v69, v118, v69 wave_ror:1 row_mask:0xf bank_mask:0xf
    v_cndmask_b32 v117, v69, v117, s[40:41]
    v_mfma_f32_16x16x32_bf16 v[100:103], v[164:167], v[188:191], v[100:103]
    buffer_load_dwordx2 v[34:35], v12, s[20:23], s51 offen nt
    v_add_f32_dpp v68, v117, v68 wave_ror:1 row_mask:0xf bank_mask:0xf
    v_mfma_f32_16x16x32_bf16 v[120:123], v[168:171], v[212:215], v[120:123]
    v_mfma_f32_16x16x32_bf16 v[124:127], v[168:171], v[172:175], v[124:127]
    v_mfma_f32_16x16x32_bf16 v[128:131], v[168:171], v[160:163], v[128:131]
    ds_read_b64_tr_b16 v[108:109], v4 offset:1440
    ds_read_b64_tr_b16 v[110:111], v4 offset:1408
    v_mfma_f32_16x16x32_bf16 v[132:135], v[168:171], v[104:107], v[132:135]
    ds_read_b64_tr_b16 v[88:89], v5 offset:1024
    ds_read_b64_tr_b16 v[90:91], v5 offset:1056
    v_mfma_f32_16x16x32_bf16 v[140:143], v[168:171], v[64:67], v[140:143]
    s_setprio 0
    v_cndmask_b32 v71, v123, v71, s[40:41]
    v_mfma_f32_16x16x32_bf16 v[144:147], v[168:171], v[196:199], v[144:147]
    s_nop 0
    v_add_f32_dpp v122, v71, v122 wave_ror:1 row_mask:0xf bank_mask:0xf
    v_cndmask_b32 v70, v122, v70, s[40:41]
    v_mfma_f32_16x16x32_bf16 v[148:151], v[168:171], v[192:195], v[148:151]
    s_nop 0
    v_add_f32_dpp v121, v70, v121 wave_ror:1 row_mask:0xf bank_mask:0xf
    v_cndmask_b32 v69, v121, v69, s[40:41]
    v_mfma_f32_16x16x32_bf16 v[152:155], v[168:171], v[188:191], v[152:155]
    s_waitcnt lgkmcnt(2)
    v_add_f32_dpp v120, v69, v120 wave_ror:1 row_mask:0xf bank_mask:0xf
    v_cvt_pk_bf16_f32 v63, v68, v120
    v_mfma_f32_16x16x32_bf16 v[76:79], v[48:51], v[172:175], v[76:79]
    ds_write_b64 v7, v[62:63] offset:512
    v_mfma_f32_16x16x32_bf16 v[80:83], v[48:51], v[160:163], v[80:83]
    ds_read_b64_tr_b16 v[180:181], v4 offset:1696
    ds_read_b64_tr_b16 v[182:183], v4 offset:1664
    v_mfma_f32_16x16x32_bf16 v[84:87], v[48:51], v[104:107], v[84:87]
    ds_read_b64_tr_b16 v[56:57], v4 offset:1952
    ds_read_b64_tr_b16 v[58:59], v4 offset:1920
    v_mfma_f32_16x16x32_bf16 v[92:95], v[48:51], v[64:67], v[92:95]
    v_mfma_f32_16x16x32_bf16 v[96:99], v[48:51], v[196:199], v[96:99]
    v_mfma_f32_16x16x32_bf16 v[100:103], v[48:51], v[192:195], v[100:103]
    v_mfma_f32_16x16x32_bf16 v[124:127], v[52:55], v[176:179], v[124:127]
    v_mfma_f32_16x16x32_bf16 v[128:131], v[52:55], v[172:175], v[128:131]
    v_mfma_f32_16x16x32_bf16 v[132:135], v[52:55], v[160:163], v[132:135]
    v_mfma_f32_16x16x32_bf16 v[140:143], v[52:55], v[104:107], v[140:143]
    s_cmp_lt_u32 s47, 4
    s_cbranch_scc0 L_hw_big
    s_waitcnt vmcnt(2)
    ds_write_b128 v251, v[232:235] offset:2048
    ds_write_b128 v251, v[236:239] offset:2176
    ds_write_b128 v251, v[240:243] offset:2304
    ds_write_b128 v251, v[244:247] offset:2432
    s_nop 1
L_hw_big:
    v_mfma_f32_16x16x32_bf16 v[144:147], v[52:55], v[64:67], v[144:147]
    v_mfma_f32_16x16x32_bf16 v[148:151], v[52:55], v[196:199], v[148:151]
    v_mfma_f32_16x16x32_bf16 v[152:155], v[52:55], v[192:195], v[152:155]
    v_mfma_f32_16x16x32_bf16 v[76:79], v[72:75], v[176:179], v[76:79]
    v_mfma_f32_16x16x32_bf16 v[80:83], v[72:75], v[172:175], v[80:83]
    v_mfma_f32_16x16x32_bf16 v[84:87], v[72:75], v[160:163], v[84:87]
    v_mfma_f32_16x16x32_bf16 v[92:95], v[72:75], v[104:107], v[92:95]
    v_mfma_f32_16x16x32_bf16 v[96:99], v[72:75], v[64:67], v[96:99]
    v_mfma_f32_16x16x32_bf16 v[100:103], v[72:75], v[196:199], v[100:103]
    s_waitcnt lgkmcnt(0)
    v_mfma_f32_16x16x32_bf16 v[124:127], v[108:111], v[88:91], v[124:127]
    s_setprio 3
    s_waitcnt lgkmcnt(0)
    s_barrier
    ds_read_b64_tr_b16 v[44:45], v4 offset:2208
    ds_read_b64_tr_b16 v[24:25], v13 offset:0
    v_mfma_f32_16x16x32_bf16 v[128:131], v[108:111], v[176:179], v[128:131]
    ds_read_b64_tr_b16 v[46:47], v4 offset:2176
    s_waitcnt vmcnt(1)
    v_lshlrev_b32 v18, 16, v32
    v_mfma_f32_16x16x32_bf16 v[132:135], v[108:111], v[172:175], v[132:135]
    ds_read_b64_tr_b16 v[136:137], v4 offset:2464
    v_and_b32 v19, v6, v32
    v_mfma_f32_16x16x32_bf16 v[140:143], v[108:111], v[160:163], v[140:143]
    ds_read_b64_tr_b16 v[138:139], v4 offset:2432
    buffer_load_dwordx2 v[36:37], v12, s[20:23], s52 offen nt
    v_mfma_f32_16x16x32_bf16 v[144:147], v[108:111], v[104:107], v[144:147]
    ds_read_b64_tr_b16 v[112:113], v4 offset:1568
    ds_read_b64_tr_b16 v[114:115], v4 offset:1536
    v_mfma_f32_16x16x32_bf16 v[148:151], v[108:111], v[64:67], v[148:151]
    ds_read_b64_tr_b16 v[156:157], v4 offset:1824
    ds_read_b64_tr_b16 v[158:159], v4 offset:1792
    v_mfma_f32_16x16x32_bf16 v[152:155], v[108:111], v[196:199], v[152:155]
    ds_read_b64_tr_b16 v[184:185], v4 offset:2080
    ds_read_b64_tr_b16 v[186:187], v4 offset:2048
    v_mfma_f32_16x16x32_bf16 v[124:127], v[180:183], v[200:203], v[124:127]
    ds_read_b64_tr_b16 v[164:165], v4 offset:2336
    ds_read_b64_tr_b16 v[166:167], v4 offset:2304
    v_mfma_f32_16x16x32_bf16 v[124:127], v[56:59], v[204:207], v[124:127]
    s_waitcnt lgkmcnt(8)
    ds_read_b64_tr_b16 v[116:117], v4 offset:2592
    ds_read_b64_tr_b16 v[118:119], v4 offset:2560
    v_mfma_f32_16x16x32_bf16 v[124:127], v[44:47], v[208:211], v[124:127]
    ds_read_b64_tr_b16 v[168:169], v4 offset:2720
    v_lshlrev_b32 v16, 16, v24
    v_mfma_f32_16x16x32_bf16 v[124:127], v[136:139], v[212:215], v[124:127]
    s_waitcnt lgkmcnt(7)
    ds_read_b64_tr_b16 v[170:171], v4 offset:2688
    v_and_b32 v17, v6, v24
    v_mfma_f32_16x16x32_bf16 v[76:79], v[112:115], v[88:91], v[76:79]
    ds_read_b64_tr_b16 v[188:189], v4 offset:2848
    v_mul_f32 v16, v16, v18
    v_mfma_f32_16x16x32_bf16 v[76:79], v[156:159], v[200:203], v[76:79]
    s_setprio 2
    s_waitcnt lgkmcnt(5)
    ds_read_b64_tr_b16 v[190:191], v4 offset:2816
    v_mul_f32 v17, v17, v19
    v_mfma_f32_16x16x32_bf16 v[76:79], v[184:187], v[204:207], v[76:79]
    ds_read_b64_tr_b16 v[68:69], v4 offset:2976
    v_cvt_pk_bf16_f32 v24, v16, v17
    v_mfma_f32_16x16x32_bf16 v[76:79], v[164:167], v[208:211], v[76:79]
    s_waitcnt lgkmcnt(4)
    ds_read_b64_tr_b16 v[70:71], v4 offset:2944
    v_lshlrev_b32 v22, 16, v33
    v_mfma_f32_16x16x32_bf16 v[76:79], v[116:119], v[212:215], v[76:79]
    ds_read_b64_tr_b16 v[120:121], v4 offset:3104
    v_and_b32 v23, v6, v33
    v_mfma_f32_16x16x32_bf16 v[128:131], v[180:183], v[88:91], v[128:131]
    ds_read_b64_tr_b16 v[122:123], v4 offset:3072
    v_lshlrev_b32 v20, 16, v25
    v_mfma_f32_16x16x32_bf16 v[128:131], v[56:59], v[200:203], v[128:131]
    v_and_b32 v21, v6, v25
    v_mul_f32 v20, v20, v22
    v_mfma_f32_16x16x32_bf16 v[128:131], v[44:47], v[204:207], v[128:131]
    v_mul_f32 v21, v21, v23
    v_cvt_pk_bf16_f32 v25, v20, v21
    v_mfma_f32_16x16x32_bf16 v[128:131], v[136:139], v[208:211], v[128:131]
    s_waitcnt lgkmcnt(2)
    buffer_store_dwordx2 v[24:25], v9, s[28:31], s55 offen
    ds_read_b64_tr_b16 v[28:29], v13 offset:512
    v_mfma_f32_16x16x32_bf16 v[128:131], v[168:171], v[212:215], v[128:131]
    s_waitcnt vmcnt(2)
    v_lshlrev_b32 v18, 16, v34
    v_and_b32 v19, v6, v34
    v_mfma_f32_16x16x32_bf16 v[80:83], v[112:115], v[176:179], v[80:83]
    ds_read_b64_tr_b16 v[60:61], v4 offset:3232
    v_lshlrev_b32 v22, 16, v35
    v_mfma_f32_16x16x32_bf16 v[80:83], v[156:159], v[88:91], v[80:83]
    ds_read_b64_tr_b16 v[62:63], v4 offset:3200
    v_and_b32 v23, v6, v35
    v_mfma_f32_16x16x32_bf16 v[80:83], v[184:187], v[200:203], v[80:83]
    v_add_f32_dpp v126, v127, v126 wave_shr:1 row_mask:0xf bank_mask:0xf bound_ctrl:0
    v_cndmask_b32 v127, v79, v127, s[40:41]
    v_mfma_f32_16x16x32_bf16 v[80:83], v[164:167], v[204:207], v[80:83]
    s_setprio 1
    v_add_f32_dpp v125, v126, v125 wave_shr:1 row_mask:0xf bank_mask:0xf bound_ctrl:0
    v_add_f32_dpp v78, v127, v78 wave_ror:1 row_mask:0xf bank_mask:0xf
    v_mfma_f32_16x16x32_bf16 v[80:83], v[116:119], v[208:211], v[80:83]
    s_waitcnt lgkmcnt(2)
    v_lshlrev_b32 v16, 16, v28
    v_and_b32 v17, v6, v28
    v_mfma_f32_16x16x32_bf16 v[80:83], v[188:191], v[212:215], v[80:83]
    v_mul_f32 v16, v16, v18
    v_mul_f32 v17, v17, v19
    v_mfma_f32_16x16x32_bf16 v[132:135], v[180:183], v[176:179], v[132:135]
    v_cvt_pk_bf16_f32 v28, v16, v17
    v_lshlrev_b32 v20, 16, v29
    v_mfma_f32_16x16x32_bf16 v[132:135], v[56:59], v[88:91], v[132:135]
    buffer_load_dwordx2 v[38:39], v12, s[20:23], s53 offen nt
    v_and_b32 v21, v6, v29
    v_mfma_f32_16x16x32_bf16 v[132:135], v[44:47], v[200:203], v[132:135]
    ds_read_b64_tr_b16 v[48:49], v4 offset:3360
    v_mul_f32 v20, v20, v22
    v_mfma_f32_16x16x32_bf16 v[132:135], v[136:139], v[204:207], v[132:135]
    ds_read_b64_tr_b16 v[50:51], v4 offset:3328
    v_mul_f32 v21, v21, v23
    v_mfma_f32_16x16x32_bf16 v[132:135], v[168:171], v[208:211], v[132:135]
    v_cvt_pk_bf16_f32 v29, v20, v21
    buffer_store_dwordx2 v[28:29], v9, s[28:31], s56 offen
    v_mfma_f32_16x16x32_bf16 v[132:135], v[68:71], v[212:215], v[132:135]
    v_cndmask_b32 v126, v78, v126, s[40:41]
    v_cndmask_b32 v79, v131, v79, s[40:41]
    v_mfma_f32_16x16x32_bf16 v[84:87], v[112:115], v[172:175], v[84:87]
    v_add_f32_dpp v77, v126, v77 wave_ror:1 row_mask:0xf bank_mask:0xf
    v_cndmask_b32 v125, v77, v125, s[40:41]
    v_mfma_f32_16x16x32_bf16 v[84:87], v[156:159], v[176:179], v[84:87]
    v_add_f32_dpp v130, v79, v130 wave_ror:1 row_mask:0xf bank_mask:0xf
    v_add_f32_dpp v76, v125, v76 wave_ror:1 row_mask:0xf bank_mask:0xf
    v_mfma_f32_16x16x32_bf16 v[84:87], v[184:187], v[88:91], v[84:87]
    v_cndmask_b32 v78, v130, v78, s[40:41]
    v_cndmask_b32 v131, v83, v131, s[40:41]
    v_mfma_f32_16x16x32_bf16 v[84:87], v[164:167], v[200:203], v[84:87]
    s_setprio 0
    v_add_f32_dpp v129, v78, v129 wave_ror:1 row_mask:0xf bank_mask:0xf
    v_cndmask_b32 v77, v129, v77, s[40:41]
    v_mfma_f32_16x16x32_bf16 v[84:87], v[116:119], v[204:207], v[84:87]
    ds_read_b64_tr_b16 v[52:53], v4 offset:3488
    v_add_f32_dpp v128, v77, v128 wave_ror:1 row_mask:0xf bank_mask:0xf
    v_mfma_f32_16x16x32_bf16 v[84:87], v[188:191], v[208:211], v[84:87]
    ds_read_b64_tr_b16 v[54:55], v4 offset:3456
    v_cvt_pk_bf16_f32 v78, v76, v128
    v_mfma_f32_16x16x32_bf16 v[84:87], v[120:123], v[212:215], v[84:87]
    v_add_f32_dpp v82, v131, v82 wave_ror:1 row_mask:0xf bank_mask:0xf
    v_cndmask_b32 v130, v82, v130, s[40:41]
    v_mfma_f32_16x16x32_bf16 v[140:143], v[180:183], v[172:175], v[140:143]
    v_cndmask_b32 v83, v135, v83, s[40:41]
    v_add_f32_dpp v81, v130, v81 wave_ror:1 row_mask:0xf bank_mask:0xf
    v_mfma_f32_16x16x32_bf16 v[140:143], v[56:59], v[176:179], v[140:143]
    v_cndmask_b32 v129, v81, v129, s[40:41]
    v_add_f32_dpp v134, v83, v134 wave_ror:1 row_mask:0xf bank_mask:0xf
    v_mfma_f32_16x16x32_bf16 v[140:143], v[44:47], v[88:91], v[140:143]
    v_add_f32_dpp v80, v129, v80 wave_ror:1 row_mask:0xf bank_mask:0xf
    v_cndmask_b32 v82, v134, v82, s[40:41]
    v_mfma_f32_16x16x32_bf16 v[140:143], v[136:139], v[200:203], v[140:143]
    s_waitcnt vmcnt(3)
    v_lshlrev_b32 v18, 16, v36
    v_add_f32_dpp v133, v82, v133 wave_ror:1 row_mask:0xf bank_mask:0xf
    v_mfma_f32_16x16x32_bf16 v[140:143], v[168:171], v[204:207], v[140:143]
    v_cndmask_b32 v81, v133, v81, s[40:41]
    v_and_b32 v19, v6, v36
    v_mfma_f32_16x16x32_bf16 v[140:143], v[68:71], v[208:211], v[140:143]
    s_waitcnt lgkmcnt(0)
    v_add_f32_dpp v132, v81, v132 wave_ror:1 row_mask:0xf bank_mask:0xf
    v_cvt_pk_bf16_f32 v79, v80, v132
    v_mfma_f32_16x16x32_bf16 v[140:143], v[60:63], v[212:215], v[140:143]
    ds_read_b64_tr_b16 v[192:193], v4 offset:3616
    ds_write_b64 v7, v[78:79] offset:1024
    v_mfma_f32_16x16x32_bf16 v[92:95], v[112:115], v[160:163], v[92:95]
    ds_read_b64_tr_b16 v[194:195], v4 offset:3584
    v_lshlrev_b32 v22, 16, v37
    v_mfma_f32_16x16x32_bf16 v[92:95], v[156:159], v[172:175], v[92:95]
    s_setprio 3
    v_and_b32 v23, v6, v37
    v_cndmask_b32 v135, v87, v135, s[40:41]
    v_mfma_f32_16x16x32_bf16 v[92:95], v[184:187], v[176:179], v[92:95]
    s_waitcnt lgkmcnt(1)
    s_barrier
    ds_read_b64_tr_b16 v[24:25], v13 offset:1024
    v_add_f32_dpp v86, v135, v86 wave_ror:1 row_mask:0xf bank_mask:0xf
    v_mfma_f32_16x16x32_bf16 v[92:95], v[164:167], v[88:91], v[92:95]
    v_cndmask_b32 v134, v86, v134, s[40:41]
    v_cndmask_b32 v87, v143, v87, s[40:41]
    v_mfma_f32_16x16x32_bf16 v[92:95], v[116:119], v[200:203], v[92:95]
    v_add_f32_dpp v85, v134, v85 wave_ror:1 row_mask:0xf bank_mask:0xf
    v_cndmask_b32 v133, v85, v133, s[40:41]
    v_mfma_f32_16x16x32_bf16 v[92:95], v[188:191], v[204:207], v[92:95]
    v_add_f32_dpp v142, v87, v142 wave_ror:1 row_mask:0xf bank_mask:0xf
    v_add_f32_dpp v84, v133, v84 wave_ror:1 row_mask:0xf bank_mask:0xf
    v_mfma_f32_16x16x32_bf16 v[92:95], v[120:123], v[208:211], v[92:95]
    v_cndmask_b32 v86, v142, v86, s[40:41]
    v_mfma_f32_16x16x32_bf16 v[92:95], v[48:51], v[212:215], v[92:95]
    s_setprio 2
    v_add_f32_dpp v141, v86, v141 wave_ror:1 row_mask:0xf bank_mask:0xf
    v_cndmask_b32 v85, v141, v85, s[40:41]
    v_mfma_f32_16x16x32_bf16 v[144:147], v[180:183], v[160:163], v[144:147]
    ds_read_b64_tr_b16 v[72:73], v4 offset:3744
    s_waitcnt lgkmcnt(1)
    v_lshlrev_b32 v16, 16, v24
    v_mfma_f32_16x16x32_bf16 v[144:147], v[56:59], v[172:175], v[144:147]
    ds_read_b64_tr_b16 v[74:75], v4 offset:3712
    v_and_b32 v17, v6, v24
    v_mfma_f32_16x16x32_bf16 v[144:147], v[44:47], v[176:179], v[144:147]
    v_mul_f32 v16, v16, v18
    v_mul_f32 v17, v17, v19
    v_mfma_f32_16x16x32_bf16 v[144:147], v[136:139], v[88:91], v[144:147]
    buffer_load_dwordx2 v[40:41], v12, s[20:23], s54 offen nt
    v_cvt_pk_bf16_f32 v24, v16, v17
    v_mfma_f32_16x16x32_bf16 v[144:147], v[168:171], v[200:203], v[144:147]
    v_lshlrev_b32 v20, 16, v25
    v_and_b32 v21, v6, v25
    v_mfma_f32_16x16x32_bf16 v[144:147], v[68:71], v[204:207], v[144:147]
    v_mul_f32 v20, v20, v22
    v_mul_f32 v21, v21, v23
    v_mfma_f32_16x16x32_bf16 v[144:147], v[60:63], v[208:211], v[144:147]
    s_setprio 1
    v_cvt_pk_bf16_f32 v25, v20, v21
    buffer_store_dwordx2 v[24:25], v9, s[28:31], s57 offen
    v_mfma_f32_16x16x32_bf16 v[144:147], v[52:55], v[212:215], v[144:147]
    v_add_f32_dpp v140, v85, v140 wave_ror:1 row_mask:0xf bank_mask:0xf
    v_cvt_pk_bf16_f32 v86, v84, v140
    v_mfma_f32_16x16x32_bf16 v[96:99], v[112:115], v[104:107], v[96:99]
    v_cndmask_b32 v143, v95, v143, s[40:41]
    v_mfma_f32_16x16x32_bf16 v[96:99], v[156:159], v[160:163], v[96:99]
    s_waitcnt vmcnt(3)
    v_lshlrev_b32 v18, 16, v38
    v_add_f32_dpp v94, v143, v94 wave_ror:1 row_mask:0xf bank_mask:0xf
    v_mfma_f32_16x16x32_bf16 v[96:99], v[184:187], v[172:175], v[96:99]
    ds_read_b64_tr_b16 v[216:217], v4 offset:3872
    v_cndmask_b32 v142, v94, v142, s[40:41]
    v_mfma_f32_16x16x32_bf16 v[96:99], v[164:167], v[176:179], v[96:99]
    ds_read_b64_tr_b16 v[218:219], v4 offset:3840
    v_add_f32_dpp v93, v142, v93 wave_ror:1 row_mask:0xf bank_mask:0xf
    v_mfma_f32_16x16x32_bf16 v[96:99], v[116:119], v[88:91], v[96:99]
    v_cndmask_b32 v141, v93, v141, s[40:41]
    v_cndmask_b32 v95, v147, v95, s[40:41]
    v_mfma_f32_16x16x32_bf16 v[96:99], v[188:191], v[200:203], v[96:99]
    s_setprio 0
    v_add_f32_dpp v92, v141, v92 wave_ror:1 row_mask:0xf bank_mask:0xf
    v_add_f32_dpp v146, v95, v146 wave_ror:1 row_mask:0xf bank_mask:0xf
    v_mfma_f32_16x16x32_bf16 v[96:99], v[120:123], v[204:207], v[96:99]
    v_cndmask_b32 v94, v146, v94, s[40:41]
    v_and_b32 v19, v6, v38
    v_mfma_f32_16x16x32_bf16 v[96:99], v[48:51], v[208:211], v[96:99]
    v_add_f32_dpp v145, v94, v145 wave_ror:1 row_mask:0xf bank_mask:0xf
    v_cndmask_b32 v93, v145, v93, s[40:41]
    v_mfma_f32_16x16x32_bf16 v[96:99], v[192:195], v[212:215], v[96:99]
    v_lshlrev_b32 v22, 16, v39
    v_add_f32_dpp v144, v93, v144 wave_ror:1 row_mask:0xf bank_mask:0xf
    v_mfma_f32_16x16x32_bf16 v[148:151], v[180:183], v[104:107], v[148:151]
    v_cvt_pk_bf16_f32 v87, v92, v144
    ds_write_b64 v7, v[86:87] offset:1536
    v_mfma_f32_16x16x32_bf16 v[148:151], v[56:59], v[160:163], v[148:151]
    v_and_b32 v23, v6, v39
    v_mfma_f32_16x16x32_bf16 v[148:151], v[44:47], v[172:175], v[148:151]
    v_cndmask_b32 v147, v99, v147, s[40:41]
    v_mfma_f32_16x16x32_bf16 v[148:151], v[136:139], v[176:179], v[148:151]
    s_setprio 3
    ds_read_b64_tr_b16 v[220:221], v4 offset:4000
    s_waitcnt lgkmcnt(1)
    s_barrier
    ds_read_b64_tr_b16 v[28:29], v13 offset:1536
    v_mfma_f32_16x16x32_bf16 v[148:151], v[168:171], v[88:91], v[148:151]
    ds_read_b64_tr_b16 v[222:223], v4 offset:3968
    v_add_f32_dpp v98, v147, v98 wave_ror:1 row_mask:0xf bank_mask:0xf
    v_mfma_f32_16x16x32_bf16 v[148:151], v[68:71], v[200:203], v[148:151]
    v_cndmask_b32 v146, v98, v146, s[40:41]
    v_mfma_f32_16x16x32_bf16 v[148:151], v[60:63], v[204:207], v[148:151]
    s_nop 0
    v_add_f32_dpp v97, v146, v97 wave_ror:1 row_mask:0xf bank_mask:0xf
    v_cndmask_b32 v145, v97, v145, s[40:41]
    v_mfma_f32_16x16x32_bf16 v[148:151], v[52:55], v[208:211], v[148:151]
    s_nop 0
    v_add_f32_dpp v96, v145, v96 wave_ror:1 row_mask:0xf bank_mask:0xf
    v_mfma_f32_16x16x32_bf16 v[148:151], v[72:75], v[212:215], v[148:151]
    v_mfma_f32_16x16x32_bf16 v[100:103], v[112:115], v[64:67], v[100:103]
    s_setprio 2
    s_waitcnt lgkmcnt(0)
    v_lshlrev_b32 v16, 16, v28
    v_and_b32 v17, v6, v28
    v_mfma_f32_16x16x32_bf16 v[100:103], v[156:159], v[104:107], v[100:103]
    v_mul_f32 v16, v16, v18
    v_mul_f32 v17, v17, v19
    v_mfma_f32_16x16x32_bf16 v[100:103], v[184:187], v[160:163], v[100:103]
    v_cvt_pk_bf16_f32 v28, v16, v17
    v_lshlrev_b32 v20, 16, v29
    v_mfma_f32_16x16x32_bf16 v[100:103], v[164:167], v[172:175], v[100:103]
    v_and_b32 v21, v6, v29
    v_mul_f32 v20, v20, v22
    v_mfma_f32_16x16x32_bf16 v[100:103], v[116:119], v[176:179], v[100:103]
    v_mul_f32 v21, v21, v23
    v_cvt_pk_bf16_f32 v29, v20, v21
    v_mfma_f32_16x16x32_bf16 v[100:103], v[188:191], v[88:91], v[100:103]
    buffer_store_dwordx2 v[28:29], v9, s[28:31], s58 offen
    v_cndmask_b32 v99, v151, v99, s[40:41]
    v_mfma_f32_16x16x32_bf16 v[100:103], v[120:123], v[200:203], v[100:103]
    s_setprio 1
    v_add_f32_dpp v150, v99, v150 wave_ror:1 row_mask:0xf bank_mask:0xf
    v_cndmask_b32 v98, v150, v98, s[40:41]
    v_mfma_f32_16x16x32_bf16 v[100:103], v[48:51], v[204:207], v[100:103]
    s_nop 0
    v_add_f32_dpp v149, v98, v149 wave_ror:1 row_mask:0xf bank_mask:0xf
    v_cndmask_b32 v97, v149, v97, s[40:41]
    v_mfma_f32_16x16x32_bf16 v[100:103], v[192:195], v[208:211], v[100:103]
    s_nop 0
    v_add_f32_dpp v148, v97, v148 wave_ror:1 row_mask:0xf bank_mask:0xf
    v_cvt_pk_bf16_f32 v98, v96, v148
    v_mfma_f32_16x16x32_bf16 v[100:103], v[216:219], v[212:215], v[100:103]
    v_mfma_f32_16x16x32_bf16 v[152:155], v[180:183], v[64:67], v[152:155]
    v_mfma_f32_16x16x32_bf16 v[152:155], v[56:59], v[104:107], v[152:155]
    v_mfma_f32_16x16x32_bf16 v[152:155], v[44:47], v[160:163], v[152:155]
    s_setprio 0
    v_mfma_f32_16x16x32_bf16 v[152:155], v[136:139], v[172:175], v[152:155]
    v_mfma_f32_16x16x32_bf16 v[152:155], v[168:171], v[176:179], v[152:155]
    v_mfma_f32_16x16x32_bf16 v[152:155], v[68:71], v[88:91], v[152:155]
    s_nop 0
    v_cndmask_b32 v151, v103, v151, s[40:41]
    v_mfma_f32_16x16x32_bf16 v[152:155], v[60:63], v[200:203], v[152:155]
    s_nop 0
    v_add_f32_dpp v102, v151, v102 wave_ror:1 row_mask:0xf bank_mask:0xf
    v_cndmask_b32 v150, v102, v150, s[40:41]
    v_mfma_f32_16x16x32_bf16 v[152:155], v[52:55], v[204:207], v[152:155]
    s_nop 0
    v_add_f32_dpp v101, v150, v101 wave_ror:1 row_mask:0xf bank_mask:0xf
    v_cndmask_b32 v149, v101, v149, s[40:41]
    v_mfma_f32_16x16x32_bf16 v[152:155], v[72:75], v[208:211], v[152:155]
    s_nop 0
    v_add_f32_dpp v100, v149, v100 wave_ror:1 row_mask:0xf bank_mask:0xf
    v_mfma_f32_16x16x32_bf16 v[152:155], v[220:223], v[212:215], v[152:155]
    s_waitcnt vmcnt(2)
    v_lshlrev_b32 v18, 16, v40
    v_and_b32 v19, v6, v40
    v_lshlrev_b32 v22, 16, v41
    v_and_b32 v23, v6, v41
    s_nop 2
    v_cndmask_b32 v103, v155, v103, s[40:41]
    s_nop 1
    v_add_f32_dpp v154, v103, v154 wave_ror:1 row_mask:0xf bank_mask:0xf
    v_cndmask_b32 v102, v154, v102, s[40:41]
    s_nop 1
    v_add_f32_dpp v153, v102, v153 wave_ror:1 row_mask:0xf bank_mask:0xf
    v_cndmask_b32 v101, v153, v101, s[40:41]
    s_nop 1
    v_add_f32_dpp v152, v101, v152 wave_ror:1 row_mask:0xf bank_mask:0xf
    v_cvt_pk_bf16_f32 v99, v100, v152
    ds_write_b64 v7, v[98:99] offset:2048
    s_waitcnt lgkmcnt(0)
    s_barrier
    ds_read_b64_tr_b16 v[24:25], v13 offset:2048
    s_waitcnt lgkmcnt(0)
    v_lshlrev_b32 v16, 16, v24
    v_and_b32 v17, v6, v24
    v_pk_mul_f32 v[16:17], v[16:17], v[18:19]
    v_cvt_pk_bf16_f32 v24, v16, v17
    v_lshlrev_b32 v20, 16, v25
    v_and_b32 v21, v6, v25
    v_pk_mul_f32 v[20:21], v[20:21], v[22:23]
    v_cvt_pk_bf16_f32 v25, v20, v21
    buffer_store_dwordx2 v[24:25], v9, s[28:31], s59 offen
    s_branch L_fin
L_hmid:
    s_nop 0
    v_lshrrev_b32 v4, 4, v2
    v_min_u32 v4, 3, v4
    v_mul_u32_u24 v4, 11328, v4
    v_and_b32 v5, 15, v2
    v_lshl_add_u32 v4, v5, 4, v4
    s_mul_i32 s67, s51, 2832
    v_add_u32 v4, s67, v4
    ds_write_b128 v4, v[56:59] offset:0
    v_lshrrev_b32 v4, 1, v2
    v_min_u32 v4, 3, v4
    v_mul_u32_u24 v4, 10368, v4
    v_and_b32 v5, 1, v2
    v_lshl_add_u32 v4, v5, 4, v4
    s_mul_i32 s67, s51, 2592
    v_add_u32 v4, s67, v4
    ds_write_b128 v4, v[56:59] offset:45312
    s_add_u32 s67, s67, 45344
    s_barrier
    s_mov_b32 m0, s67
    s_waitcnt vmcnt(7)
    buffer_load_dwordx4 v3, s[28:31], s66 offen offset:0 lds
    buffer_load_dwordx4 v3, s[28:31], s66 offen offset:1024 lds
    s_mov_b32 exec_hi, 0
    buffer_load_dwordx4 v3, s[28:31], s66 offen offset:2048 lds
    s_mov_b64 exec, -1
    s_add_u32 s67, s67, 10368
    s_add_u32 s66, s66, 16384
    s_mov_b32 m0, s67
    s_waitcnt vmcnt(7)
    buffer_load_dwordx4 v3, s[28:31], s66 offen offset:0 lds
    buffer_load_dwordx4 v3, s[28:31], s66 offen offset:1024 lds
    s_mov_b32 exec_hi, 0
    buffer_load_dwordx4 v3, s[28:31], s66 offen offset:2048 lds
    s_mov_b64 exec, -1
    s_add_u32 s67, s67, 10368
    s_add_u32 s66, s66, 16384
    s_mov_b32 m0, s67
    s_waitcnt vmcnt(7)
    buffer_load_dwordx4 v3, s[28:31], s66 offen offset:0 lds
    buffer_load_dwordx4 v3, s[28:31], s66 offen offset:1024 lds
    s_mov_b32 exec_hi, 0
    buffer_load_dwordx4 v3, s[28:31], s66 offen offset:2048 lds
    s_mov_b64 exec, -1
    s_add_u32 s67, s67, 10368
    s_add_u32 s66, s66, 16384
    s_mov_b32 m0, s67
    s_waitcnt vmcnt(7)
    buffer_load_dwordx4 v3, s[28:31], s66 offen offset:0 lds
    buffer_load_dwordx4 v3, s[28:31], s66 offen offset:1024 lds
    s_mov_b32 exec_hi, 0
    buffer_load_dwordx4 v3, s[28:31], s66 offen offset:2048 lds
    s_mov_b64 exec, -1
    s_add_u32 s67, s67, 10368
    s_add_u32 s66, s66, 16384
    s_waitcnt vmcnt(7)
    s_add_u32 m0, s54, 0
    s_nop 0
    buffer_load_dwordx4 v52, s[20:23], 0 offen lds
    s_add_u32 m0, s54, 3840
    s_nop 0
    buffer_load_dwordx4 v48, s[24:27], s52 offen lds
    s_waitcnt vmcnt(7)
    s_add_u32 m0, s54, 1024
    s_nop 0
    buffer_load_dwordx4 v53, s[20:23], 0 offen lds
    s_add_u32 m0, s54, 4864
    s_nop 0
    buffer_load_dwordx4 v49, s[24:27], s52 offen lds
    s_waitcnt vmcnt(7)
    s_add_u32 m0, s54, 2048
    s_nop 0
    buffer_load_dwordx4 v54, s[20:23], 0 offen lds
    s_add_u32 m0, s54, 5888
    s_mov_b32 exec_hi, 0
    s_nop 0
    buffer_load_dwordx4 v50, s[24:27], s52 offen lds
    s_mov_b64 exec, -1
    s_waitcnt vmcnt(7)
    s_add_u32 m0, s54, 3072
    s_mov_b32 exec_hi, 0xffff
    s_nop 0
    buffer_load_dwordx4 v55, s[20:23], 0 offen lds
    s_mov_b64 exec, -1
    s_waitcnt lgkmcnt(0)
    s_mov_b32 s36, s44
    s_mov_b32 s37, s45
    s_mov_b32 s38, 33554432
    s_mov_b32 s39, 0x20000
    v_mov_b32 v6, 0xffff0000
    v_bfe_u32 v1, v2, 2, 2
    v_mul_u32_u24 v222, 320, v1
    v_lshrrev_b32 v1, 4, v2
    v_lshl_add_u32 v222, v1, 5, v222
    v_and_b32 v1, 3, v2
    v_lshl_add_u32 v222, v1, 3, v222
    v_add_u32 v222, s54, v222
    s_mul_i32 s43, s3, 655360
    s_lshl_b32 s55, s50, 7
    s_add_u32 s43, s43, s55
    v_lshrrev_b32 v1, 3, v2
    v_lshlrev_b32 v223, 15, v1
    v_and_b32 v1, 7, v2
    v_lshl_add_u32 v223, v1, 4, v223
    v_add_u32 v223, s43, v223
    v_lshrrev_b32 v3, 5, v2
    v_mul_u32_u24 v116, 1216, v3
    v_add3_u32 v116, v116, v222, 64
    v_add_u32 v116, 192, v116
    v_mul_u32_u24 v117, 131064, v3
    v_sub_u32 v117, v223, v117
    v_add_u32 v117, 524288, v117
    s_lshl_b32 s43, s3, 5
    s_add_u32 s43, s43, s6
    s_lshl_b32 s43, s43, 7
    s_lshl_b32 s55, s47, 3
    s_add_u32 s43, s43, s55
    s_add_u32 s43, s43, 5242880
    v_mov_b32 v224, s43
    s_mov_b32 s42, 32768
    v_add_u32 v225, s42, v224
    s_mul_i32 s60, s58, 0x9E3779B1
    s_add_u32 s60, s60, 0x7F4A7C15
    s_mul_i32 s61, s59, 0x85EBCA6B
    s_add_u32 s61, s61, s60
    v_mov_b32 v228, s60
    v_mov_b32 v229, s61
    v_and_b32 v100, v6, v217
    v_bfi_b32 v101, v6, v216, v217
    v_and_b32 v102, 0xffff, v216
    v_alignbit_b32 v103, v217, v217, 16
    v_alignbit_b32 v104, v216, v216, 16
    v_and_b32 v105, v6, v219
    v_bfi_b32 v106, v6, v218, v219
    v_and_b32 v107, 0xffff, v218
    v_alignbit_b32 v108, v219, v219, 16
    v_alignbit_b32 v109, v218, v218, 16
    v_and_b32 v110, v6, v221
    v_bfi_b32 v111, v6, v220, v221
    v_and_b32 v112, 0xffff, v220
    v_alignbit_b32 v113, v221, v221, 16
    v_alignbit_b32 v114, v220, v220, 16
    v_lshrrev_b32 v3, 4, v2
    v_bfe_u32 v14, v2, 2, 2
    v_and_b32 v15, 3, v2
    v_lshl_add_u32 v1, v3, 3, v14
    s_mul_i32 s66, s47, 2592
    s_add_u32 s66, s66, 45320
    v_add_u32 v44, v15, v1
    v_lshl_add_u32 v5, v44, 3, s66
    s_add_u32 s66, s66, 24
    v_mov_b32 v10, s66
    s_bitcmp1_b32 s47, 0
    s_cselect_b32 s67, 0, 16
    s_lshl_b32 s70, s70, s67
    s_and_b32 s70, s70, 0xffff0000
    v_mov_b32 v8, s70
    s_lshl_b32 s78, s78, 16
    v_add_f32 v8, s78, v8
    s_lshl_b32 s71, s71, s67
    s_and_b32 s71, s71, 0xffff0000
    v_mov_b32 v11, s71
    s_lshl_b32 s79, s79, 16
    v_add_f32 v11, s79, v11
    v_cvt_pk_bf16_f32 v8, v8, v11
    s_mul_i32 s66, s47, 2832
    s_add_u32 s66, s66, 248
    v_lshlrev_b32 v44, 2, v15
    v_sub_u32 v44, v44, v1
    v_lshl_add_u32 v4, v44, 3, s66
    s_mov_b32 s20, s8
    s_mov_b32 s21, s9
    s_mov_b32 s22, 2621440
    s_mov_b32 s23, 0x20000
    s_mov_b32 s28, s72
    s_mov_b32 s29, s73
    s_mov_b32 s30, 5242880
    s_mov_b32 s31, 0x20000
    s_mov_b32 s40, 0
    s_mov_b32 s41, 0x80000000
    v_and_b32 v45, 1, v3
    v_lshrrev_b32 v46, 1, v3
    v_lshlrev_b32 v1, 6, v15
    v_lshl_add_u32 v1, v45, 2, v1
    v_add_u32 v1, v1, v14
    s_lshl_b32 s66, s47, 3
    v_add_u32 v1, s66, v1
    v_mul_u32_u24 v1, 1280, v1
    v_lshl_add_u32 v12, v46, 4, v1
    v_add_u32 v9, v12, v1
    s_lshl_b32 s43, s49, 4
    s_add_u32 s66, s43, s48
    s_mul_i32 s67, s3, 320
    s_add_u32 s67, s67, s43
    s_add_u32 s50, s66, 655360
    s_add_u32 s55, s67, 1310720
    s_add_u32 s51, s66, 983040
    s_add_u32 s56, s67, 1966080
    s_add_u32 s52, s66, 1310720
    s_add_u32 s57, s67, 2621440
    s_mul_i32 s66, s47, 1600
    s_add_u32 s66, s66, 86784
    v_lshl_add_u32 v7, v2, 3, s66
    v_lshl_add_u32 v1, v46, 3, v14
    v_mul_u32_u24 v1, 1600, v1
    v_lshl_add_u32 v44, v45, 2, v15
    v_lshl_add_u32 v1, v44, 3, v1
    s_lshl_b32 s66, s47, 6
    s_add_u32 s66, s66, 86784
    v_add_u32 v13, s66, v1
    s_waitcnt vmcnt(0)
    ds_read_b64_tr_b16 v[120:121], v222 offset:0
    ds_read_b64_tr_b16 v[122:123], v222 offset:1280
    ds_read_b64_tr_b16 v[124:125], v222 offset:2560
    ds_read_b64_tr_b16 v[126:127], v222 offset:3840
    ds_read_b64_tr_b16 v[128:129], v222 offset:5120
    ds_read_b64_tr_b16 v[130:131], v222 offset:128
    ds_read_b64_tr_b16 v[132:133], v222 offset:1408
    ds_read_b64_tr_b16 v[134:135], v222 offset:2688
    ds_read_b64_tr_b16 v[136:137], v222 offset:3968
    ds_read_b64_tr_b16 v[138:139], v222 offset:5248
    ds_read_b64_tr_b16 v[140:141], v116 offset:0
    ds_read_b64_tr_b16 v[142:143], v116 offset:1280
    ds_read_b64_tr_b16 v[146:147], v116 offset:3840
    s_waitcnt lgkmcnt(12)
    v_dot2_f32_bf16 v36, v120, v100, 0
    v_dot2_f32_bf16 v37, v121, v103, 0
    v_dot2_f32_bf16 v38, v121, v100, 0
    s_waitcnt lgkmcnt(11)
    v_dot2_f32_bf16 v39, v122, v103, 0
    v_dot2_f32_bf16 v40, v122, v100, 0
    v_dot2_f32_bf16 v41, v123, v103, 0
    v_dot2_f32_bf16 v42, v123, v100, 0
    s_waitcnt lgkmcnt(10)
    v_dot2_f32_bf16 v43, v124, v103, 0
    v_dot2_f32_bf16 v36, v121, v101, v36
    v_dot2_f32_bf16 v37, v122, v104, v37
    v_dot2_f32_bf16 v38, v122, v101, v38
    v_dot2_f32_bf16 v39, v123, v104, v39
    v_dot2_f32_bf16 v40, v123, v101, v40
    v_dot2_f32_bf16 v41, v124, v104, v41
    v_dot2_f32_bf16 v42, v124, v101, v42
    v_dot2_f32_bf16 v43, v125, v104, v43
    v_dot2_f32_bf16 v36, v122, v102, v36
    v_dot2_f32_bf16 v38, v123, v102, v38
    v_dot2_f32_bf16 v40, v124, v102, v40
    v_dot2_f32_bf16 v42, v125, v102, v42
    s_waitcnt lgkmcnt(9)
    v_lshlrev_b32 v150, 16, v126
    v_and_b32 v151, v6, v126
    v_lshlrev_b32 v152, 16, v127
    v_and_b32 v153, v6, v127
    s_waitcnt lgkmcnt(8)
    v_lshlrev_b32 v154, 16, v128
    v_and_b32 v155, v6, v128
    v_lshlrev_b32 v156, 16, v129
    v_and_b32 v157, v6, v129
    v_pk_mul_f32 v[36:37], v[36:37], v[150:151]
    v_pk_mul_f32 v[38:39], v[38:39], v[152:153]
    v_pk_mul_f32 v[40:41], v[40:41], v[154:155]
    v_pk_mul_f32 v[42:43], v[42:43], v[156:157]
    v_cvt_pk_bf16_f32 v232, v36, v37
    v_cvt_pk_bf16_f32 v233, v38, v39
    v_cvt_pk_bf16_f32 v234, v40, v41
    v_cvt_pk_bf16_f32 v235, v42, v43
    buffer_store_dwordx4 v[232:235], v223, s[36:39], 0 offen sc1
    s_waitcnt lgkmcnt(7)
    v_dot2_f32_bf16 v36, v130, v105, 0
    v_dot2_f32_bf16 v37, v131, v108, 0
    v_dot2_f32_bf16 v38, v131, v105, 0
    s_waitcnt lgkmcnt(6)
    v_dot2_f32_bf16 v39, v132, v108, 0
    v_dot2_f32_bf16 v40, v132, v105, 0
    v_dot2_f32_bf16 v41, v133, v108, 0
    v_dot2_f32_bf16 v42, v133, v105, 0
    s_waitcnt lgkmcnt(5)
    v_dot2_f32_bf16 v43, v134, v108, 0
    v_dot2_f32_bf16 v36, v131, v106, v36
    v_dot2_f32_bf16 v37, v132, v109, v37
    v_dot2_f32_bf16 v38, v132, v106, v38
    v_dot2_f32_bf16 v39, v133, v109, v39
    v_dot2_f32_bf16 v40, v133, v106, v40
    v_dot2_f32_bf16 v41, v134, v109, v41
    v_dot2_f32_bf16 v42, v134, v106, v42
    v_dot2_f32_bf16 v43, v135, v109, v43
    v_dot2_f32_bf16 v36, v132, v107, v36
    v_dot2_f32_bf16 v38, v133, v107, v38
    v_dot2_f32_bf16 v40, v134, v107, v40
    v_dot2_f32_bf16 v42, v135, v107, v42
    s_waitcnt lgkmcnt(4)
    v_lshlrev_b32 v150, 16, v136
    v_and_b32 v151, v6, v136
    v_lshlrev_b32 v152, 16, v137
    v_and_b32 v153, v6, v137
    s_waitcnt lgkmcnt(3)
    v_lshlrev_b32 v154, 16, v138
    v_and_b32 v155, v6, v138
    v_lshlrev_b32 v156, 16, v139
    v_and_b32 v157, v6, v139
    v_pk_mul_f32 v[36:37], v[36:37], v[150:151]
    v_pk_mul_f32 v[38:39], v[38:39], v[152:153]
    v_pk_mul_f32 v[40:41], v[40:41], v[154:155]
    v_pk_mul_f32 v[42:43], v[42:43], v[156:157]
    v_cvt_pk_bf16_f32 v236, v36, v37
    v_cvt_pk_bf16_f32 v237, v38, v39
    v_cvt_pk_bf16_f32 v238, v40, v41
    v_cvt_pk_bf16_f32 v239, v42, v43
    s_mov_b32 s43, 262144
    buffer_store_dwordx4 v[236:239], v223, s[36:39], s43 offen sc1
    s_waitcnt lgkmcnt(2)
    v_dot2_f32_bf16 v36, v140, v110, 0
    v_dot2_f32_bf16 v37, v141, v113, 0
    v_dot2_f32_bf16 v38, v141, v110, 0
    s_waitcnt lgkmcnt(1)
    v_dot2_f32_bf16 v39, v142, v113, 0
    v_dot2_f32_bf16 v36, v141, v111, v36
    v_dot2_f32_bf16 v37, v142, v114, v37
    v_dot2_f32_bf16 v38, v142, v111, v38
    v_dot2_f32_bf16 v39, v143, v114, v39
    v_dot2_f32_bf16 v36, v142, v112, v36
    v_dot2_f32_bf16 v38, v143, v112, v38
    s_waitcnt lgkmcnt(0)
    v_lshlrev_b32 v150, 16, v146
    v_and_b32 v151, v6, v146
    v_lshlrev_b32 v152, 16, v147
    v_and_b32 v153, v6, v147
    v_pk_mul_f32 v[36:37], v[36:37], v[150:151]
    v_pk_mul_f32 v[38:39], v[38:39], v[152:153]
    v_cvt_pk_bf16_f32 v240, v36, v37
    v_cvt_pk_bf16_f32 v241, v38, v39
    buffer_store_dwordx2 v[240:241], v117, s[36:39], 0 offen sc1
    s_mov_b64 exec, 1
    ds_write_b16 v10, v8
    ds_write_b16_d16_hi v10, v8 offset:20736
    s_mov_b64 exec, -1
    ds_read_b64_tr_b16 v[212:213], v5 offset:1024
    ds_read_b64_tr_b16 v[214:215], v5 offset:1056
    ds_read_b64_tr_b16 v[208:209], v5 offset:1280
    ds_read_b64_tr_b16 v[210:211], v5 offset:1312
    ds_read_b64_tr_b16 v[204:205], v5 offset:1536
    ds_read_b64_tr_b16 v[206:207], v5 offset:1568
    ds_read_b64_tr_b16 v[200:201], v5 offset:1792
    ds_read_b64_tr_b16 v[202:203], v5 offset:1824
    ds_read_b64_tr_b16 v[196:197], v5 offset:2048
    ds_read_b64_tr_b16 v[198:199], v5 offset:2080
    ds_read_b64_tr_b16 v[192:193], v5 offset:2304
    ds_read_b64_tr_b16 v[194:195], v5 offset:2336
    ds_read_b64_tr_b16 v[188:189], v5 offset:768
    ds_read_b64_tr_b16 v[190:191], v5 offset:800
    ds_read_b64_tr_b16 v[184:185], v5 offset:512
    ds_read_b64_tr_b16 v[186:187], v5 offset:544
    ds_read_b64_tr_b16 v[180:181], v5 offset:256
    ds_read_b64_tr_b16 v[182:183], v5 offset:288
    ds_read_b64_tr_b16 v[176:177], v5 offset:0
    ds_read_b64_tr_b16 v[178:179], v5 offset:32
    s_waitcnt lgkmcnt(0)
    s_barrier
    s_waitcnt vmcnt(0)
    s_mov_b64 exec, 1
    buffer_store_dwordx2 v[228:229], v224, s[36:39], 0 offen
    s_mov_b64 exec, -1
    v_lshrrev_b32 v1, 2, v2
    v_mul_u32_u24 v1, 1280, v1
    v_and_b32 v14, 3, v2
    v_lshlrev_b32 v14, 7, v14
    v_min_u32 v14, 316, v14
    v_add_u32 v1, v1, v14
    s_lshl_b32 s43, s6, 2
    s_and_b32 s66, s47, 3
    s_add_u32 s43, s43, s66
    s_mul_i32 s43, s43, 20480
    s_add_u32 s43, s43, s48
    buffer_load_dword v14, v1, s[20:23], s43 offen
    s_mov_b64 exec, 1
    buffer_store_dwordx2 v[228:229], v225, s[36:39], 0 offen sc1
    s_mov_b64 exec, -1
L_p2_mid:
    s_setprio 3
    ds_read_b64_tr_b16 v[48:49], v4 offset:32
    ds_read_b64_tr_b16 v[50:51], v4 offset:0
    ds_read_b64_tr_b16 v[52:53], v4 offset:160
    ds_read_b64_tr_b16 v[54:55], v4 offset:128
    s_waitcnt lgkmcnt(2)
    v_mfma_f32_16x16x32_bf16 v[44:47], v[48:51], v[212:215], 0
    ds_read_b64_tr_b16 v[56:57], v4 offset:288
    ds_read_b64_tr_b16 v[58:59], v4 offset:256
    v_mfma_f32_16x16x32_bf16 v[60:63], v[48:51], v[208:211], 0
    ds_read_b64_tr_b16 v[68:69], v4 offset:416
    ds_read_b64_tr_b16 v[70:71], v4 offset:384
    v_mfma_f32_16x16x32_bf16 v[64:67], v[48:51], v[204:207], 0
    ds_read_b64_tr_b16 v[76:77], v4 offset:672
    ds_read_b64_tr_b16 v[78:79], v4 offset:640
    v_mfma_f32_16x16x32_bf16 v[72:75], v[48:51], v[200:203], 0
    ds_read_b64_tr_b16 v[84:85], v4 offset:928
    ds_read_b64_tr_b16 v[86:87], v4 offset:896
    v_mfma_f32_16x16x32_bf16 v[80:83], v[48:51], v[196:199], 0
    ds_read_b64_tr_b16 v[92:93], v4 offset:544
    ds_read_b64_tr_b16 v[94:95], v4 offset:512
    v_mfma_f32_16x16x32_bf16 v[88:91], v[48:51], v[192:195], 0
    s_waitcnt lgkmcnt(8)
    ds_read_b64_tr_b16 v[100:101], v4 offset:800
    ds_read_b64_tr_b16 v[102:103], v4 offset:768
    v_mfma_f32_16x16x32_bf16 v[96:99], v[52:55], v[188:191], 0
    ds_read_b64_tr_b16 v[108:109], v4 offset:1056
    ds_read_b64_tr_b16 v[110:111], v4 offset:1024
    v_mfma_f32_16x16x32_bf16 v[104:107], v[52:55], v[212:215], 0
    v_mfma_f32_16x16x32_bf16 v[112:115], v[52:55], v[208:211], 0
    ds_read_b64_tr_b16 v[120:121], v4 offset:1184
    ds_read_b64_tr_b16 v[122:123], v4 offset:1152
    v_mfma_f32_16x16x32_bf16 v[116:119], v[52:55], v[204:207], 0
    v_mfma_f32_16x16x32_bf16 v[124:127], v[52:55], v[200:203], 0
    v_mfma_f32_16x16x32_bf16 v[128:131], v[52:55], v[196:199], 0
    v_mfma_f32_16x16x32_bf16 v[132:135], v[52:55], v[192:195], 0
    ds_read_b64_tr_b16 v[136:137], v4 offset:1312
    ds_read_b64_tr_b16 v[138:139], v4 offset:1280
    v_mfma_f32_16x16x32_bf16 v[44:47], v[56:59], v[188:191], v[44:47]
    v_mfma_f32_16x16x32_bf16 v[60:63], v[56:59], v[212:215], v[60:63]
    v_mfma_f32_16x16x32_bf16 v[64:67], v[56:59], v[208:211], v[64:67]
    v_mfma_f32_16x16x32_bf16 v[72:75], v[56:59], v[204:207], v[72:75]
    ds_read_b64_tr_b16 v[140:141], v4 offset:1440
    ds_read_b64_tr_b16 v[142:143], v4 offset:1408
    v_mfma_f32_16x16x32_bf16 v[80:83], v[56:59], v[200:203], v[80:83]
    v_mfma_f32_16x16x32_bf16 v[88:91], v[56:59], v[196:199], v[88:91]
    s_waitcnt lgkmcnt(2)
    v_mfma_f32_16x16x32_bf16 v[96:99], v[68:71], v[184:187], v[96:99]
    v_mfma_f32_16x16x32_bf16 v[104:107], v[68:71], v[188:191], v[104:107]
    s_setprio 2
    v_mfma_f32_16x16x32_bf16 v[112:115], v[68:71], v[212:215], v[112:115]
    ds_read_b64_tr_b16 v[144:145], v4 offset:1568
    ds_read_b64_tr_b16 v[146:147], v4 offset:1536
    v_mfma_f32_16x16x32_bf16 v[116:119], v[68:71], v[208:211], v[116:119]
    v_mfma_f32_16x16x32_bf16 v[124:127], v[68:71], v[204:207], v[124:127]
    v_mfma_f32_16x16x32_bf16 v[128:131], v[68:71], v[200:203], v[128:131]
    v_mfma_f32_16x16x32_bf16 v[132:135], v[68:71], v[196:199], v[132:135]
    v_mfma_f32_16x16x32_bf16 v[96:99], v[76:79], v[180:183], v[96:99]
    ds_read_b64_tr_b16 v[148:149], v4 offset:1696
    ds_read_b64_tr_b16 v[150:151], v4 offset:1664
    v_mfma_f32_16x16x32_bf16 v[96:99], v[84:87], v[176:179], v[96:99]
    v_mfma_f32_16x16x32_bf16 v[44:47], v[92:95], v[184:187], v[44:47]
    v_mfma_f32_16x16x32_bf16 v[44:47], v[100:103], v[180:183], v[44:47]
    v_mfma_f32_16x16x32_bf16 v[44:47], v[108:111], v[176:179], v[44:47]
    v_mfma_f32_16x16x32_bf16 v[104:107], v[76:79], v[184:187], v[104:107]
    v_mfma_f32_16x16x32_bf16 v[104:107], v[84:87], v[180:183], v[104:107]
    ds_read_b64_tr_b16 v[152:153], v4 offset:1824
    ds_read_b64_tr_b16 v[154:155], v4 offset:1792
    v_mfma_f32_16x16x32_bf16 v[104:107], v[120:123], v[176:179], v[104:107]
    s_cmp_lt_u32 s47, 4
    s_cbranch_scc0 L_hp_mid
    buffer_load_dwordx2 v[252:253], v249, s[36:39], 0 offen sc1
    s_nop 1
L_hp_mid:
    v_add_f32_dpp v98, v99, v98 wave_shr:1 row_mask:0xf bank_mask:0xf bound_ctrl:0
    v_cndmask_b32 v99, v47, v99, s[40:41]
    v_mfma_f32_16x16x32_bf16 v[60:63], v[92:95], v[188:191], v[60:63]
    v_add_f32_dpp v97, v98, v97 wave_shr:1 row_mask:0xf bank_mask:0xf bound_ctrl:0
    v_add_f32_dpp v46, v99, v46 wave_ror:1 row_mask:0xf bank_mask:0xf
    v_mfma_f32_16x16x32_bf16 v[60:63], v[100:103], v[184:187], v[60:63]
    v_cndmask_b32 v98, v46, v98, s[40:41]
    v_cndmask_b32 v47, v107, v47, s[40:41]
    v_mfma_f32_16x16x32_bf16 v[60:63], v[108:111], v[180:183], v[60:63]
    v_add_f32_dpp v45, v98, v45 wave_ror:1 row_mask:0xf bank_mask:0xf
    v_cndmask_b32 v97, v45, v97, s[40:41]
    v_mfma_f32_16x16x32_bf16 v[60:63], v[136:139], v[176:179], v[60:63]
    v_add_f32_dpp v106, v47, v106 wave_ror:1 row_mask:0xf bank_mask:0xf
    v_add_f32_dpp v44, v97, v44 wave_ror:1 row_mask:0xf bank_mask:0xf
    v_mfma_f32_16x16x32_bf16 v[112:115], v[76:79], v[188:191], v[112:115]
    ds_read_b64_tr_b16 v[156:157], v4 offset:1952
    v_cndmask_b32 v46, v106, v46, s[40:41]
    v_mfma_f32_16x16x32_bf16 v[112:115], v[84:87], v[184:187], v[112:115]
    ds_read_b64_tr_b16 v[158:159], v4 offset:1920
    v_add_f32_dpp v105, v46, v105 wave_ror:1 row_mask:0xf bank_mask:0xf
    v_mfma_f32_16x16x32_bf16 v[112:115], v[120:123], v[180:183], v[112:115]
    s_waitcnt lgkmcnt(2)
    v_cndmask_b32 v45, v105, v45, s[40:41]
    v_cndmask_b32 v107, v63, v107, s[40:41]
    v_mfma_f32_16x16x32_bf16 v[112:115], v[140:143], v[176:179], v[112:115]
    v_add_f32_dpp v104, v45, v104 wave_ror:1 row_mask:0xf bank_mask:0xf
    v_cvt_pk_bf16_f32 v46, v44, v104
    v_mfma_f32_16x16x32_bf16 v[64:67], v[92:95], v[212:215], v[64:67]
    s_setprio 1
    v_add_f32_dpp v62, v107, v62 wave_ror:1 row_mask:0xf bank_mask:0xf
    v_cndmask_b32 v106, v62, v106, s[40:41]
    v_mfma_f32_16x16x32_bf16 v[64:67], v[100:103], v[188:191], v[64:67]
    s_nop 0
    v_add_f32_dpp v61, v106, v61 wave_ror:1 row_mask:0xf bank_mask:0xf
    v_cndmask_b32 v105, v61, v105, s[40:41]
    v_mfma_f32_16x16x32_bf16 v[64:67], v[108:111], v[184:187], v[64:67]
    v_cndmask_b32 v63, v115, v63, s[40:41]
    v_add_f32_dpp v60, v105, v60 wave_ror:1 row_mask:0xf bank_mask:0xf
    v_mfma_f32_16x16x32_bf16 v[64:67], v[136:139], v[180:183], v[64:67]
    v_add_f32_dpp v114, v63, v114 wave_ror:1 row_mask:0xf bank_mask:0xf
    v_cndmask_b32 v62, v114, v62, s[40:41]
    v_mfma_f32_16x16x32_bf16 v[64:67], v[144:147], v[176:179], v[64:67]
    s_nop 0
    v_add_f32_dpp v113, v62, v113 wave_ror:1 row_mask:0xf bank_mask:0xf
    v_cndmask_b32 v61, v113, v61, s[40:41]
    v_mfma_f32_16x16x32_bf16 v[116:119], v[76:79], v[212:215], v[116:119]
    s_nop 0
    v_add_f32_dpp v112, v61, v112 wave_ror:1 row_mask:0xf bank_mask:0xf
    v_cvt_pk_bf16_f32 v47, v60, v112
    v_mfma_f32_16x16x32_bf16 v[116:119], v[84:87], v[188:191], v[116:119]
    ds_write_b64 v7, v[46:47] offset:0
    v_cndmask_b32 v115, v67, v115, s[40:41]
    v_mfma_f32_16x16x32_bf16 v[116:119], v[120:123], v[184:187], v[116:119]
    s_nop 0
    v_add_f32_dpp v66, v115, v66 wave_ror:1 row_mask:0xf bank_mask:0xf
    v_cndmask_b32 v114, v66, v114, s[40:41]
    v_mfma_f32_16x16x32_bf16 v[116:119], v[140:143], v[180:183], v[116:119]
    s_nop 0
    v_add_f32_dpp v65, v114, v65 wave_ror:1 row_mask:0xf bank_mask:0xf
    v_cndmask_b32 v113, v65, v113, s[40:41]
    v_mfma_f32_16x16x32_bf16 v[116:119], v[148:151], v[176:179], v[116:119]
    s_cmp_lt_u32 s47, 4
    s_cbranch_scc0 L_hl_mid
    s_mov_b32 s65, 0
    s_waitcnt vmcnt(0)
    s_branch L_pchk_bmid
L_poll_bmid:
    s_sleep 1
    buffer_load_dwordx2 v[252:253], v249, s[36:39], 0 offen sc1
    s_waitcnt vmcnt(0)
L_pchk_bmid:
    v_cmp_ne_u64 vcc, s[60:61], v[252:253]
    s_add_u32 s65, s65, 1
    s_cmp_gt_u32 s65, 0x40000
    s_cbranch_scc1 L_pdone_bmid
    s_cmp_eq_u64 vcc, 0
    s_cbranch_scc1 L_pdone_bmid
    s_cmp_lt_u32 s65, 6
    s_cbranch_scc1 L_poll_bmid
    buffer_load_dwordx2 v[254:255], v249, s[36:39], s42 offen sc1
    s_waitcnt vmcnt(0)
    v_cmp_ne_u64 s[68:69], s[60:61], v[254:255]
    s_nop 1
    s_and_b64 vcc, vcc, s[68:69]
    s_cbranch_scc1 L_poll_bmid
L_pdone_bmid:
    s_mov_b32 s43, 16384
    buffer_load_dwordx4 v[232:235], v250, s[36:39], s43 offen sc1
    s_mov_b32 s43, 49152
    buffer_load_dwordx4 v[236:239], v250, s[36:39], s43 offen sc1
    s_nop 1
L_hl_mid:
    v_add_f32_dpp v64, v113, v64 wave_ror:1 row_mask:0xf bank_mask:0xf
    v_mfma_f32_16x16x32_bf16 v[72:75], v[92:95], v[208:211], v[72:75]
    v_mfma_f32_16x16x32_bf16 v[72:75], v[100:103], v[212:215], v[72:75]
    v_mfma_f32_16x16x32_bf16 v[72:75], v[108:111], v[188:191], v[72:75]
    v_mfma_f32_16x16x32_bf16 v[72:75], v[136:139], v[184:187], v[72:75]
    s_nop 0
    v_cndmask_b32 v67, v119, v67, s[40:41]
    v_mfma_f32_16x16x32_bf16 v[72:75], v[144:147], v[180:183], v[72:75]
    s_nop 0
    v_add_f32_dpp v118, v67, v118 wave_ror:1 row_mask:0xf bank_mask:0xf
    v_cndmask_b32 v66, v118, v66, s[40:41]
    v_mfma_f32_16x16x32_bf16 v[72:75], v[152:155], v[176:179], v[72:75]
    s_nop 0
    v_add_f32_dpp v117, v66, v117 wave_ror:1 row_mask:0xf bank_mask:0xf
    v_cndmask_b32 v65, v117, v65, s[40:41]
    v_mfma_f32_16x16x32_bf16 v[124:127], v[76:79], v[208:211], v[124:127]
    s_nop 0
    v_add_f32_dpp v116, v65, v116 wave_ror:1 row_mask:0xf bank_mask:0xf
    v_cvt_pk_bf16_f32 v66, v64, v116
    v_mfma_f32_16x16x32_bf16 v[124:127], v[84:87], v[212:215], v[124:127]
    v_cndmask_b32 v119, v75, v119, s[40:41]
    v_mfma_f32_16x16x32_bf16 v[124:127], v[120:123], v[188:191], v[124:127]
    s_nop 0
    v_add_f32_dpp v74, v119, v74 wave_ror:1 row_mask:0xf bank_mask:0xf
    v_cndmask_b32 v118, v74, v118, s[40:41]
    v_mfma_f32_16x16x32_bf16 v[124:127], v[140:143], v[184:187], v[124:127]
    s_nop 0
    v_add_f32_dpp v73, v118, v73 wave_ror:1 row_mask:0xf bank_mask:0xf
    v_cndmask_b32 v117, v73, v117, s[40:41]
    v_mfma_f32_16x16x32_bf16 v[124:127], v[148:151], v[180:183], v[124:127]
    s_waitcnt lgkmcnt(0)
    v_add_f32_dpp v72, v117, v72 wave_ror:1 row_mask:0xf bank_mask:0xf
    v_mfma_f32_16x16x32_bf16 v[124:127], v[156:159], v[176:179], v[124:127]
    s_setprio 0
    ds_read_b64_tr_b16 v[160:161], v4 offset:22816
    ds_read_b64_tr_b16 v[162:163], v4 offset:22784
    v_mfma_f32_16x16x32_bf16 v[80:83], v[92:95], v[204:207], v[80:83]
    ds_read_b64_tr_b16 v[164:165], v5 offset:21504
    ds_read_b64_tr_b16 v[166:167], v5 offset:21536
    v_mfma_f32_16x16x32_bf16 v[80:83], v[100:103], v[208:211], v[80:83]
    ds_read_b64_tr_b16 v[168:169], v4 offset:23072
    v_cndmask_b32 v75, v127, v75, s[40:41]
    v_mfma_f32_16x16x32_bf16 v[80:83], v[108:111], v[212:215], v[80:83]
    ds_read_b64_tr_b16 v[170:171], v4 offset:23040
    v_add_f32_dpp v126, v75, v126 wave_ror:1 row_mask:0xf bank_mask:0xf
    v_mfma_f32_16x16x32_bf16 v[80:83], v[136:139], v[188:191], v[80:83]
    ds_read_b64_tr_b16 v[172:173], v5 offset:21248
    v_cndmask_b32 v74, v126, v74, s[40:41]
    v_mfma_f32_16x16x32_bf16 v[80:83], v[144:147], v[184:187], v[80:83]
    ds_read_b64_tr_b16 v[174:175], v5 offset:21280
    v_add_f32_dpp v125, v74, v125 wave_ror:1 row_mask:0xf bank_mask:0xf
    v_mfma_f32_16x16x32_bf16 v[80:83], v[152:155], v[180:183], v[80:83]
    ds_read_b64_tr_b16 v[48:49], v4 offset:23328
    buffer_load_dwordx4 v[32:35], v12, s[20:23], s50 offen nt
    v_mfma_f32_16x16x32_bf16 v[128:131], v[76:79], v[204:207], v[128:131]
    ds_read_b64_tr_b16 v[50:51], v4 offset:23296
    v_cndmask_b32 v73, v125, v73, s[40:41]
    v_mfma_f32_16x16x32_bf16 v[128:131], v[84:87], v[208:211], v[128:131]
    ds_read_b64_tr_b16 v[52:53], v5 offset:20992
    v_add_f32_dpp v124, v73, v124 wave_ror:1 row_mask:0xf bank_mask:0xf
    v_mfma_f32_16x16x32_bf16 v[128:131], v[120:123], v[212:215], v[128:131]
    ds_read_b64_tr_b16 v[54:55], v5 offset:21024
    v_cvt_pk_bf16_f32 v67, v72, v124
    v_mfma_f32_16x16x32_bf16 v[128:131], v[140:143], v[188:191], v[128:131]
    ds_read_b64_tr_b16 v[192:193], v4 offset:23584
    ds_write_b64 v7, v[66:67] offset:512
    v_mfma_f32_16x16x32_bf16 v[128:131], v[148:151], v[184:187], v[128:131]
    ds_read_b64_tr_b16 v[194:195], v4 offset:23552
    ds_read_b64_tr_b16 v[56:57], v5 offset:20736
    v_mfma_f32_16x16x32_bf16 v[128:131], v[156:159], v[180:183], v[128:131]
    ds_read_b64_tr_b16 v[58:59], v5 offset:20768
    v_mfma_f32_16x16x32_bf16 v[88:91], v[92:95], v[200:203], v[88:91]
    v_mfma_f32_16x16x32_bf16 v[88:91], v[100:103], v[204:207], v[88:91]
    s_cmp_lt_u32 s47, 4
    s_cbranch_scc0 L_hw_mid
    s_waitcnt vmcnt(1)
    ds_write_b128 v251, v[232:235] offset:2048
    ds_write_b128 v251, v[236:239] offset:24704
    s_nop 1
L_hw_mid:
    v_mfma_f32_16x16x32_bf16 v[88:91], v[108:111], v[208:211], v[88:91]
    v_mfma_f32_16x16x32_bf16 v[88:91], v[136:139], v[212:215], v[88:91]
    v_mfma_f32_16x16x32_bf16 v[88:91], v[144:147], v[188:191], v[88:91]
    v_mfma_f32_16x16x32_bf16 v[88:91], v[152:155], v[184:187], v[88:91]
    v_mfma_f32_16x16x32_bf16 v[132:135], v[76:79], v[200:203], v[132:135]
    v_mfma_f32_16x16x32_bf16 v[132:135], v[84:87], v[204:207], v[132:135]
    v_mfma_f32_16x16x32_bf16 v[132:135], v[120:123], v[208:211], v[132:135]
    v_mfma_f32_16x16x32_bf16 v[132:135], v[140:143], v[212:215], v[132:135]
    s_setprio 3
    s_waitcnt lgkmcnt(0)
    s_barrier
    ds_read_b64_tr_b16 v[68:69], v4 offset:2080
    ds_read_b64_tr_b16 v[70:71], v4 offset:2048
    v_mfma_f32_16x16x32_bf16 v[132:135], v[148:151], v[188:191], v[132:135]
    ds_read_b64_tr_b16 v[196:197], v4 offset:2208
    ds_read_b64_tr_b16 v[198:199], v4 offset:2176
    v_mfma_f32_16x16x32_bf16 v[132:135], v[156:159], v[184:187], v[132:135]
    ds_read_b64_tr_b16 v[96:97], v4 offset:2336
    ds_read_b64_tr_b16 v[98:99], v4 offset:2304
    v_mfma_f32_16x16x32_bf16 v[104:107], v[160:163], v[164:167], 0
    ds_read_b64_tr_b16 v[60:61], v4 offset:2464
    ds_read_b64_tr_b16 v[62:63], v4 offset:2432
    v_mfma_f32_16x16x32_bf16 v[104:107], v[168:171], v[172:175], v[104:107]
    ds_read_b64_tr_b16 v[44:45], v4 offset:22688
    ds_read_b64_tr_b16 v[46:47], v4 offset:22656
    v_mfma_f32_16x16x32_bf16 v[104:107], v[48:51], v[52:55], v[104:107]
    ds_read_b64_tr_b16 v[112:113], v5 offset:21760
    ds_read_b64_tr_b16 v[114:115], v5 offset:21792
    v_mfma_f32_16x16x32_bf16 v[104:107], v[192:195], v[56:59], v[104:107]
    s_waitcnt lgkmcnt(8)
    ds_read_b64_tr_b16 v[116:117], v4 offset:22944
    ds_read_b64_tr_b16 v[118:119], v4 offset:22912
    v_mfma_f32_16x16x32_bf16 v[80:83], v[68:71], v[176:179], v[80:83]
    ds_read_b64_tr_b16 v[72:73], v4 offset:23200
    ds_read_b64_tr_b16 v[74:75], v4 offset:23168
    v_mfma_f32_16x16x32_bf16 v[128:131], v[196:199], v[176:179], v[128:131]
    ds_read_b64_tr_b16 v[64:65], v4 offset:23456
    v_add_f32_dpp v106, v107, v106 wave_shr:1 row_mask:0xf bank_mask:0xf bound_ctrl:0
    v_mfma_f32_16x16x32_bf16 v[88:91], v[68:71], v[180:183], v[88:91]
    s_waitcnt lgkmcnt(7)
    ds_read_b64_tr_b16 v[66:67], v4 offset:23424
    v_add_f32_dpp v105, v106, v105 wave_shr:1 row_mask:0xf bank_mask:0xf bound_ctrl:0
    v_mfma_f32_16x16x32_bf16 v[88:91], v[96:99], v[176:179], v[88:91]
    ds_read_b64_tr_b16 v[92:93], v4 offset:23712
    ds_read_b64_tr_b16 v[94:95], v4 offset:23680
    v_mfma_f32_16x16x32_bf16 v[132:135], v[196:199], v[180:183], v[132:135]
    s_setprio 2
    ds_read_b64_tr_b16 v[100:101], v4 offset:23840
    v_cndmask_b32 v127, v83, v127, s[40:41]
    v_mfma_f32_16x16x32_bf16 v[132:135], v[60:63], v[176:179], v[132:135]
    s_waitcnt lgkmcnt(5)
    ds_read_b64_tr_b16 v[102:103], v4 offset:23808
    v_add_f32_dpp v82, v127, v82 wave_ror:1 row_mask:0xf bank_mask:0xf
    v_mfma_f32_16x16x32_bf16 v[108:111], v[44:47], v[112:115], 0
    ds_read_b64_tr_b16 v[136:137], v5 offset:22016
    v_cndmask_b32 v126, v82, v126, s[40:41]
    v_mfma_f32_16x16x32_bf16 v[108:111], v[116:119], v[164:167], v[108:111]
    ds_read_b64_tr_b16 v[138:139], v5 offset:22048
    buffer_load_dwordx4 v[36:39], v12, s[20:23], s51 offen nt
    v_mfma_f32_16x16x32_bf16 v[108:111], v[72:75], v[172:175], v[108:111]
    s_waitcnt lgkmcnt(4)
    ds_read_b64_tr_b16 v[144:145], v4 offset:23968
    v_add_f32_dpp v81, v126, v81 wave_ror:1 row_mask:0xf bank_mask:0xf
    v_mfma_f32_16x16x32_bf16 v[108:111], v[64:67], v[52:55], v[108:111]
    ds_read_b64_tr_b16 v[146:147], v4 offset:23936
    v_cndmask_b32 v125, v81, v125, s[40:41]
    v_mfma_f32_16x16x32_bf16 v[108:111], v[92:95], v[56:59], v[108:111]
    ds_read_b64_tr_b16 v[152:153], v4 offset:24096
    v_add_f32_dpp v80, v125, v80 wave_ror:1 row_mask:0xf bank_mask:0xf
    v_mfma_f32_16x16x32_bf16 v[76:79], v[160:163], v[112:115], 0
    ds_read_b64_tr_b16 v[154:155], v4 offset:24064
    v_cndmask_b32 v83, v131, v83, s[40:41]
    v_mfma_f32_16x16x32_bf16 v[76:79], v[168:171], v[164:167], v[76:79]
    ds_read_b64_tr_b16 v[200:201], v5 offset:22272
    v_add_f32_dpp v130, v83, v130 wave_ror:1 row_mask:0xf bank_mask:0xf
    v_mfma_f32_16x16x32_bf16 v[76:79], v[48:51], v[172:175], v[76:79]
    ds_read_b64_tr_b16 v[202:203], v5 offset:22304
    v_cndmask_b32 v82, v130, v82, s[40:41]
    v_mfma_f32_16x16x32_bf16 v[76:79], v[192:195], v[52:55], v[76:79]
    s_waitcnt lgkmcnt(4)
    ds_read_b64_tr_b16 v[84:85], v4 offset:24224
    v_add_f32_dpp v129, v82, v129 wave_ror:1 row_mask:0xf bank_mask:0xf
    v_mfma_f32_16x16x32_bf16 v[76:79], v[100:103], v[56:59], v[76:79]
    ds_read_b64_tr_b16 v[86:87], v4 offset:24192
    v_cndmask_b32 v81, v129, v81, s[40:41]
    v_mfma_f32_16x16x32_bf16 v[204:207], v[44:47], v[136:139], 0
    s_setprio 1
    ds_read_b64_tr_b16 v[120:121], v4 offset:24352
    v_add_f32_dpp v128, v81, v128 wave_ror:1 row_mask:0xf bank_mask:0xf
    v_mfma_f32_16x16x32_bf16 v[204:207], v[116:119], v[112:115], v[204:207]
    ds_read_b64_tr_b16 v[122:123], v4 offset:24320
    v_cvt_pk_bf16_f32 v82, v80, v128
    v_mfma_f32_16x16x32_bf16 v[204:207], v[72:75], v[164:167], v[204:207]
    ds_read_b64_tr_b16 v[208:209], v5 offset:22528
    v_cndmask_b32 v131, v91, v131, s[40:41]
    v_mfma_f32_16x16x32_bf16 v[204:207], v[64:67], v[172:175], v[204:207]
    ds_read_b64_tr_b16 v[210:211], v5 offset:22560
    v_add_f32_dpp v90, v131, v90 wave_ror:1 row_mask:0xf bank_mask:0xf
    v_mfma_f32_16x16x32_bf16 v[204:207], v[92:95], v[52:55], v[204:207]
    v_cndmask_b32 v130, v90, v130, s[40:41]
    v_cndmask_b32 v91, v135, v91, s[40:41]
    v_mfma_f32_16x16x32_bf16 v[204:207], v[144:147], v[56:59], v[204:207]
    v_add_f32_dpp v89, v130, v89 wave_ror:1 row_mask:0xf bank_mask:0xf
    v_cndmask_b32 v129, v89, v129, s[40:41]
    v_mfma_f32_16x16x32_bf16 v[140:143], v[160:163], v[136:139], 0
    v_add_f32_dpp v134, v91, v134 wave_ror:1 row_mask:0xf bank_mask:0xf
    v_add_f32_dpp v88, v129, v88 wave_ror:1 row_mask:0xf bank_mask:0xf
    v_mfma_f32_16x16x32_bf16 v[140:143], v[168:171], v[112:115], v[140:143]
    v_cndmask_b32 v90, v134, v90, s[40:41]
    v_cndmask_b32 v107, v111, v107, s[40:41]
    v_mfma_f32_16x16x32_bf16 v[140:143], v[48:51], v[164:167], v[140:143]
    ds_read_b64_tr_b16 v[212:213], v4 offset:24480
    v_add_f32_dpp v133, v90, v133 wave_ror:1 row_mask:0xf bank_mask:0xf
    v_mfma_f32_16x16x32_bf16 v[140:143], v[192:195], v[172:175], v[140:143]
    ds_read_b64_tr_b16 v[214:215], v4 offset:24448
    v_cndmask_b32 v89, v133, v89, s[40:41]
    v_mfma_f32_16x16x32_bf16 v[140:143], v[100:103], v[52:55], v[140:143]
    s_waitcnt lgkmcnt(2)
    v_add_f32_dpp v132, v89, v132 wave_ror:1 row_mask:0xf bank_mask:0xf
    v_cvt_pk_bf16_f32 v83, v88, v132
    v_mfma_f32_16x16x32_bf16 v[140:143], v[152:155], v[56:59], v[140:143]
    s_setprio 0
    ds_write_b64 v7, v[82:83] offset:1024
    v_add_f32_dpp v110, v107, v110 wave_ror:1 row_mask:0xf bank_mask:0xf
    v_mfma_f32_16x16x32_bf16 v[216:219], v[44:47], v[200:203], 0
    v_cndmask_b32 v106, v110, v106, s[40:41]
    v_cndmask_b32 v111, v79, v111, s[40:41]
    v_mfma_f32_16x16x32_bf16 v[216:219], v[116:119], v[136:139], v[216:219]
    v_add_f32_dpp v109, v106, v109 wave_ror:1 row_mask:0xf bank_mask:0xf
    v_cndmask_b32 v105, v109, v105, s[40:41]
    v_mfma_f32_16x16x32_bf16 v[216:219], v[72:75], v[112:115], v[216:219]
    v_add_f32_dpp v78, v111, v78 wave_ror:1 row_mask:0xf bank_mask:0xf
    v_add_f32_dpp v108, v105, v108 wave_ror:1 row_mask:0xf bank_mask:0xf
    v_mfma_f32_16x16x32_bf16 v[216:219], v[64:67], v[164:167], v[216:219]
    v_cndmask_b32 v110, v78, v110, s[40:41]
    v_cndmask_b32 v79, v207, v79, s[40:41]
    v_mfma_f32_16x16x32_bf16 v[216:219], v[92:95], v[172:175], v[216:219]
    ds_read_b64_tr_b16 v[220:221], v4 offset:24608
    v_add_f32_dpp v77, v110, v77 wave_ror:1 row_mask:0xf bank_mask:0xf
    v_mfma_f32_16x16x32_bf16 v[216:219], v[144:147], v[52:55], v[216:219]
    ds_read_b64_tr_b16 v[222:223], v4 offset:24576
    v_cndmask_b32 v109, v77, v109, s[40:41]
    v_mfma_f32_16x16x32_bf16 v[216:219], v[84:87], v[56:59], v[216:219]
    ds_read_b64_tr_b16 v[224:225], v5 offset:22784
    v_add_f32_dpp v76, v109, v76 wave_ror:1 row_mask:0xf bank_mask:0xf
    v_mfma_f32_16x16x32_bf16 v[228:231], v[160:163], v[200:203], 0
    ds_read_b64_tr_b16 v[226:227], v5 offset:22816
    v_cvt_pk_bf16_f32 v110, v108, v76
    v_mfma_f32_16x16x32_bf16 v[228:231], v[168:171], v[136:139], v[228:231]
    v_add_f32_dpp v206, v79, v206 wave_ror:1 row_mask:0xf bank_mask:0xf
    v_cndmask_b32 v78, v206, v78, s[40:41]
    v_mfma_f32_16x16x32_bf16 v[228:231], v[48:51], v[112:115], v[228:231]
    buffer_load_dwordx4 v[40:43], v12, s[20:23], s52 offen nt
    v_add_f32_dpp v205, v78, v205 wave_ror:1 row_mask:0xf bank_mask:0xf
    v_mfma_f32_16x16x32_bf16 v[228:231], v[192:195], v[164:167], v[228:231]
    v_cndmask_b32 v77, v205, v77, s[40:41]
    v_cndmask_b32 v207, v143, v207, s[40:41]
    v_mfma_f32_16x16x32_bf16 v[228:231], v[100:103], v[172:175], v[228:231]
    s_setprio 3
    v_add_f32_dpp v204, v77, v204 wave_ror:1 row_mask:0xf bank_mask:0xf
    v_add_f32_dpp v142, v207, v142 wave_ror:1 row_mask:0xf bank_mask:0xf
    v_mfma_f32_16x16x32_bf16 v[228:231], v[152:155], v[52:55], v[228:231]
    v_cndmask_b32 v206, v142, v206, s[40:41]
    s_waitcnt vmcnt(2)
    v_lshlrev_b32 v18, 16, v32
    v_mfma_f32_16x16x32_bf16 v[228:231], v[120:123], v[56:59], v[228:231]
    ds_read_b64_tr_b16 v[236:237], v4 offset:24736
    v_add_f32_dpp v141, v206, v141 wave_ror:1 row_mask:0xf bank_mask:0xf
    v_mfma_f32_16x16x32_bf16 v[232:235], v[44:47], v[208:211], 0
    ds_read_b64_tr_b16 v[238:239], v4 offset:24704
    v_cndmask_b32 v205, v141, v205, s[40:41]
    v_mfma_f32_16x16x32_bf16 v[232:235], v[116:119], v[200:203], v[232:235]
    v_and_b32 v19, v6, v32
    v_add_f32_dpp v140, v205, v140 wave_ror:1 row_mask:0xf bank_mask:0xf
    v_mfma_f32_16x16x32_bf16 v[232:235], v[72:75], v[136:139], v[232:235]
    v_cvt_pk_bf16_f32 v111, v204, v140
    ds_write_b64 v7, v[110:111] offset:12800
    v_mfma_f32_16x16x32_bf16 v[232:235], v[64:67], v[112:115], v[232:235]
    v_lshlrev_b32 v22, 16, v33
    v_and_b32 v23, v6, v33
    v_mfma_f32_16x16x32_bf16 v[232:235], v[92:95], v[164:167], v[232:235]
    v_cndmask_b32 v143, v219, v143, s[40:41]
    v_cndmask_b32 v219, v231, v219, s[40:41]
    v_mfma_f32_16x16x32_bf16 v[232:235], v[144:147], v[172:175], v[232:235]
    s_setprio 2
    s_waitcnt lgkmcnt(0)
    s_barrier
    ds_read_b64_tr_b16 v[24:25], v13 offset:0
    ds_read_b64_tr_b16 v[26:27], v13 offset:6400
    v_mfma_f32_16x16x32_bf16 v[232:235], v[84:87], v[52:55], v[232:235]
    v_add_f32_dpp v218, v143, v218 wave_ror:1 row_mask:0xf bank_mask:0xf
    v_cndmask_b32 v142, v218, v142, s[40:41]
    v_mfma_f32_16x16x32_bf16 v[232:235], v[212:215], v[56:59], v[232:235]
    v_add_f32_dpp v230, v219, v230 wave_ror:1 row_mask:0xf bank_mask:0xf
    v_add_f32_dpp v217, v142, v217 wave_ror:1 row_mask:0xf bank_mask:0xf
    v_mfma_f32_16x16x32_bf16 v[240:243], v[160:163], v[208:211], 0
    ds_read_b64_tr_b16 v[244:245], v4 offset:24864
    v_cndmask_b32 v141, v217, v141, s[40:41]
    v_mfma_f32_16x16x32_bf16 v[240:243], v[168:171], v[200:203], v[240:243]
    ds_read_b64_tr_b16 v[246:247], v4 offset:24832
    v_add_f32_dpp v216, v141, v216 wave_ror:1 row_mask:0xf bank_mask:0xf
    v_mfma_f32_16x16x32_bf16 v[240:243], v[48:51], v[136:139], v[240:243]
    ds_read_b64_tr_b16 v[248:249], v5 offset:23040
    v_cndmask_b32 v218, v230, v218, s[40:41]
    v_mfma_f32_16x16x32_bf16 v[240:243], v[192:195], v[112:115], v[240:243]
    ds_read_b64_tr_b16 v[250:251], v5 offset:23072
    s_waitcnt lgkmcnt(4)
    v_lshlrev_b32 v16, 16, v24
    v_mfma_f32_16x16x32_bf16 v[240:243], v[100:103], v[164:167], v[240:243]
    v_and_b32 v17, v6, v24
    v_mul_f32 v16, v16, v18
    v_mfma_f32_16x16x32_bf16 v[240:243], v[152:155], v[172:175], v[240:243]
    s_setprio 1
    v_mul_f32 v17, v17, v19
    v_cvt_pk_bf16_f32 v24, v16, v17
    v_mfma_f32_16x16x32_bf16 v[240:243], v[120:123], v[52:55], v[240:243]
    v_lshlrev_b32 v20, 16, v25
    v_and_b32 v21, v6, v25
    v_mfma_f32_16x16x32_bf16 v[240:243], v[220:223], v[56:59], v[240:243]
    v_mul_f32 v20, v20, v22
    v_mul_f32 v21, v21, v23
    v_mfma_f32_16x16x32_bf16 v[252:255], v[44:47], v[224:227], 0
    v_cvt_pk_bf16_f32 v25, v20, v21
    v_lshlrev_b32 v18, 16, v34
    v_mfma_f32_16x16x32_bf16 v[252:255], v[116:119], v[208:211], v[252:255]
    v_and_b32 v19, v6, v34
    v_lshlrev_b32 v16, 16, v26
    v_mfma_f32_16x16x32_bf16 v[252:255], v[72:75], v[200:203], v[252:255]
    ds_read_b64_tr_b16 v[148:149], v4 offset:24992
    v_and_b32 v17, v6, v26
    v_mfma_f32_16x16x32_bf16 v[252:255], v[64:67], v[136:139], v[252:255]
    ds_read_b64_tr_b16 v[150:151], v4 offset:24960
    v_mul_f32 v16, v16, v18
    v_mfma_f32_16x16x32_bf16 v[252:255], v[92:95], v[112:115], v[252:255]
    v_mul_f32 v17, v17, v19
    v_cvt_pk_bf16_f32 v26, v16, v17
    v_mfma_f32_16x16x32_bf16 v[252:255], v[144:147], v[164:167], v[252:255]
    s_setprio 0
    v_lshlrev_b32 v22, 16, v35
    v_and_b32 v23, v6, v35
    v_mfma_f32_16x16x32_bf16 v[252:255], v[84:87], v[172:175], v[252:255]
    v_lshlrev_b32 v20, 16, v27
    v_and_b32 v21, v6, v27
    v_mfma_f32_16x16x32_bf16 v[252:255], v[212:215], v[52:55], v[252:255]
    v_mul_f32 v20, v20, v22
    v_mul_f32 v21, v21, v23
    v_mfma_f32_16x16x32_bf16 v[252:255], v[236:239], v[56:59], v[252:255]
    v_cvt_pk_bf16_f32 v27, v20, v21
    buffer_store_dwordx4 v[24:27], v9, s[28:31], s55 offen
    v_mfma_f32_16x16x32_bf16 v[188:191], v[160:163], v[224:227], 0
    v_add_f32_dpp v229, v218, v229 wave_ror:1 row_mask:0xf bank_mask:0xf
    v_cndmask_b32 v217, v229, v217, s[40:41]
    v_mfma_f32_16x16x32_bf16 v[188:191], v[168:171], v[208:211], v[188:191]
    v_cndmask_b32 v231, v235, v231, s[40:41]
    v_add_f32_dpp v228, v217, v228 wave_ror:1 row_mask:0xf bank_mask:0xf
    v_mfma_f32_16x16x32_bf16 v[188:191], v[48:51], v[200:203], v[188:191]
    v_cvt_pk_bf16_f32 v218, v216, v228
    v_add_f32_dpp v234, v231, v234 wave_ror:1 row_mask:0xf bank_mask:0xf
    v_mfma_f32_16x16x32_bf16 v[188:191], v[192:195], v[136:139], v[188:191]
    ds_read_b64_tr_b16 v[156:157], v4 offset:25120
    v_cndmask_b32 v230, v234, v230, s[40:41]
    v_mfma_f32_16x16x32_bf16 v[188:191], v[100:103], v[112:115], v[188:191]
    ds_read_b64_tr_b16 v[158:159], v4 offset:25088
    v_add_f32_dpp v233, v230, v233 wave_ror:1 row_mask:0xf bank_mask:0xf
    v_mfma_f32_16x16x32_bf16 v[188:191], v[152:155], v[164:167], v[188:191]
    s_setprio 3
    v_cndmask_b32 v229, v233, v229, s[40:41]
    v_cndmask_b32 v235, v243, v235, s[40:41]
    v_mfma_f32_16x16x32_bf16 v[188:191], v[120:123], v[172:175], v[188:191]
    v_add_f32_dpp v232, v229, v232 wave_ror:1 row_mask:0xf bank_mask:0xf
    v_add_f32_dpp v242, v235, v242 wave_ror:1 row_mask:0xf bank_mask:0xf
    v_mfma_f32_16x16x32_bf16 v[188:191], v[220:223], v[52:55], v[188:191]
    s_waitcnt lgkmcnt(2)
    v_cndmask_b32 v234, v242, v234, s[40:41]
    s_waitcnt vmcnt(2)
    v_lshlrev_b32 v18, 16, v36
    v_mfma_f32_16x16x32_bf16 v[188:191], v[244:247], v[56:59], v[188:191]
    v_add_f32_dpp v241, v234, v241 wave_ror:1 row_mask:0xf bank_mask:0xf
    v_cndmask_b32 v233, v241, v233, s[40:41]
    v_mfma_f32_16x16x32_bf16 v[184:187], v[44:47], v[248:251], 0
    v_and_b32 v19, v6, v36
    v_add_f32_dpp v240, v233, v240 wave_ror:1 row_mask:0xf bank_mask:0xf
    v_mfma_f32_16x16x32_bf16 v[184:187], v[116:119], v[224:227], v[184:187]
    s_setprio 2
    v_cvt_pk_bf16_f32 v219, v232, v240
    ds_write_b64 v7, v[218:219] offset:13312
    v_mfma_f32_16x16x32_bf16 v[184:187], v[72:75], v[208:211], v[184:187]
    v_lshlrev_b32 v22, 16, v37
    v_and_b32 v23, v6, v37
    v_mfma_f32_16x16x32_bf16 v[184:187], v[64:67], v[200:203], v[184:187]
    v_cndmask_b32 v243, v255, v243, s[40:41]
    v_cndmask_b32 v255, v191, v255, s[40:41]
    v_mfma_f32_16x16x32_bf16 v[184:187], v[92:95], v[136:139], v[184:187]
    s_waitcnt lgkmcnt(0)
    s_barrier
    ds_read_b64_tr_b16 v[28:29], v13 offset:512
    ds_read_b64_tr_b16 v[30:31], v13 offset:6912
    v_mfma_f32_16x16x32_bf16 v[184:187], v[144:147], v[112:115], v[184:187]
    v_add_f32_dpp v254, v243, v254 wave_ror:1 row_mask:0xf bank_mask:0xf
    v_cndmask_b32 v242, v254, v242, s[40:41]
    v_mfma_f32_16x16x32_bf16 v[184:187], v[84:87], v[164:167], v[184:187]
    v_add_f32_dpp v190, v255, v190 wave_ror:1 row_mask:0xf bank_mask:0xf
    v_add_f32_dpp v253, v242, v253 wave_ror:1 row_mask:0xf bank_mask:0xf
    v_mfma_f32_16x16x32_bf16 v[184:187], v[212:215], v[172:175], v[184:187]
    s_setprio 1
    v_cndmask_b32 v241, v253, v241, s[40:41]
    v_cndmask_b32 v254, v190, v254, s[40:41]
    v_mfma_f32_16x16x32_bf16 v[184:187], v[236:239], v[52:55], v[184:187]
    v_add_f32_dpp v252, v241, v252 wave_ror:1 row_mask:0xf bank_mask:0xf
    v_add_f32_dpp v189, v254, v189 wave_ror:1 row_mask:0xf bank_mask:0xf
    v_mfma_f32_16x16x32_bf16 v[184:187], v[148:151], v[56:59], v[184:187]
    v_cndmask_b32 v253, v189, v253, s[40:41]
    v_mfma_f32_16x16x32_bf16 v[68:71], v[160:163], v[248:251], 0
    s_waitcnt lgkmcnt(0)
    v_lshlrev_b32 v16, 16, v28
    v_and_b32 v17, v6, v28
    v_mfma_f32_16x16x32_bf16 v[68:71], v[168:171], v[224:227], v[68:71]
    v_mul_f32 v16, v16, v18
    v_mul_f32 v17, v17, v19
    v_mfma_f32_16x16x32_bf16 v[68:71], v[48:51], v[208:211], v[68:71]
    v_cvt_pk_bf16_f32 v28, v16, v17
    v_lshlrev_b32 v20, 16, v29
    v_mfma_f32_16x16x32_bf16 v[68:71], v[192:195], v[200:203], v[68:71]
    s_setprio 0
    v_and_b32 v21, v6, v29
    v_mul_f32 v20, v20, v22
    v_mfma_f32_16x16x32_bf16 v[68:71], v[100:103], v[136:139], v[68:71]
    v_mul_f32 v21, v21, v23
    v_cvt_pk_bf16_f32 v29, v20, v21
    v_mfma_f32_16x16x32_bf16 v[68:71], v[152:155], v[112:115], v[68:71]
    v_lshlrev_b32 v18, 16, v38
    v_and_b32 v19, v6, v38
    v_mfma_f32_16x16x32_bf16 v[68:71], v[120:123], v[164:167], v[68:71]
    v_lshlrev_b32 v16, 16, v30
    v_and_b32 v17, v6, v30
    v_mfma_f32_16x16x32_bf16 v[68:71], v[220:223], v[172:175], v[68:71]
    v_mul_f32 v16, v16, v18
    v_mul_f32 v17, v17, v19
    v_mfma_f32_16x16x32_bf16 v[68:71], v[244:247], v[52:55], v[68:71]
    v_cvt_pk_bf16_f32 v30, v16, v17
    v_lshlrev_b32 v22, 16, v39
    v_mfma_f32_16x16x32_bf16 v[68:71], v[156:159], v[56:59], v[68:71]
    v_and_b32 v23, v6, v39
    v_lshlrev_b32 v20, 16, v31
    v_and_b32 v21, v6, v31
    v_mul_f32 v20, v20, v22
    v_mul_f32 v21, v21, v23
    v_cvt_pk_bf16_f32 v31, v20, v21
    buffer_store_dwordx4 v[28:31], v9, s[28:31], s56 offen
    v_add_f32_dpp v188, v253, v188 wave_ror:1 row_mask:0xf bank_mask:0xf
    v_cvt_pk_bf16_f32 v254, v252, v188
    v_cndmask_b32 v191, v187, v191, s[40:41]
    v_cndmask_b32 v187, v71, v187, s[40:41]
    s_waitcnt vmcnt(2)
    v_lshlrev_b32 v18, 16, v40
    v_add_f32_dpp v186, v191, v186 wave_ror:1 row_mask:0xf bank_mask:0xf
    v_cndmask_b32 v190, v186, v190, s[40:41]
    v_add_f32_dpp v70, v187, v70 wave_ror:1 row_mask:0xf bank_mask:0xf
    v_cndmask_b32 v186, v70, v186, s[40:41]
    v_add_f32_dpp v185, v190, v185 wave_ror:1 row_mask:0xf bank_mask:0xf
    v_cndmask_b32 v189, v185, v189, s[40:41]
    v_add_f32_dpp v69, v186, v69 wave_ror:1 row_mask:0xf bank_mask:0xf
    v_cndmask_b32 v185, v69, v185, s[40:41]
    v_add_f32_dpp v184, v189, v184 wave_ror:1 row_mask:0xf bank_mask:0xf
    v_and_b32 v19, v6, v40
    v_add_f32_dpp v68, v185, v68 wave_ror:1 row_mask:0xf bank_mask:0xf
    v_cvt_pk_bf16_f32 v255, v184, v68
    ds_write_b64 v7, v[254:255] offset:13824
    s_waitcnt lgkmcnt(0)
    s_barrier
    ds_read_b64_tr_b16 v[24:25], v13 offset:1024
    ds_read_b64_tr_b16 v[26:27], v13 offset:7424
    s_waitcnt lgkmcnt(0)
    v_lshlrev_b32 v16, 16, v24
    v_and_b32 v17, v6, v24
    v_pk_mul_f32 v[16:17], v[16:17], v[18:19]
    v_cvt_pk_bf16_f32 v24, v16, v17
    v_lshlrev_b32 v22, 16, v41
    v_and_b32 v23, v6, v41
    v_lshlrev_b32 v20, 16, v25
    v_and_b32 v21, v6, v25
    v_pk_mul_f32 v[20:21], v[20:21], v[22:23]
    v_cvt_pk_bf16_f32 v25, v20, v21
    v_lshlrev_b32 v18, 16, v42
    v_and_b32 v19, v6, v42
    v_lshlrev_b32 v16, 16, v26
    v_and_b32 v17, v6, v26
    v_pk_mul_f32 v[16:17], v[16:17], v[18:19]
    v_cvt_pk_bf16_f32 v26, v16, v17
    v_lshlrev_b32 v22, 16, v43
    v_and_b32 v23, v6, v43
    v_lshlrev_b32 v20, 16, v27
    v_and_b32 v21, v6, v27
    v_pk_mul_f32 v[20:21], v[20:21], v[22:23]
    v_cvt_pk_bf16_f32 v27, v20, v21
    buffer_store_dwordx4 v[24:27], v9, s[28:31], s57 offen
    s_branch L_fin
L_bidle:
    s_nop 0
    s_barrier
    s_add_u32 m0, s54, 0
    s_nop 0
    buffer_load_dwordx4 v52, s[20:23], 0 offen lds
    s_add_u32 m0, s54, 3840
    s_nop 0
    buffer_load_dwordx4 v48, s[24:27], s52 offen lds
    s_add_u32 m0, s54, 1024
    s_nop 0
    buffer_load_dwordx4 v53, s[20:23], 0 offen lds
    s_add_u32 m0, s54, 4864
    s_nop 0
    buffer_load_dwordx4 v49, s[24:27], s52 offen lds
    s_add_u32 m0, s54, 2048
    s_nop 0
    buffer_load_dwordx4 v54, s[20:23], 0 offen lds
    s_add_u32 m0, s54, 5888
    s_mov_b32 exec_hi, 0
    s_nop 0
    buffer_load_dwordx4 v50, s[24:27], s52 offen lds
    s_mov_b64 exec, -1
    s_add_u32 m0, s54, 3072
    s_mov_b32 exec_hi, 0xffff
    s_nop 0
    buffer_load_dwordx4 v55, s[20:23], 0 offen lds
    s_mov_b64 exec, -1
    s_waitcnt lgkmcnt(0)
    s_mov_b32 s36, s44
    s_mov_b32 s37, s45
    s_mov_b32 s38, 33554432
    s_mov_b32 s39, 0x20000
    v_mov_b32 v6, 0xffff0000
    v_bfe_u32 v1, v2, 2, 2
    v_mul_u32_u24 v222, 320, v1
    v_lshrrev_b32 v1, 4, v2
    v_lshl_add_u32 v222, v1, 5, v222
    v_and_b32 v1, 3, v2
    v_lshl_add_u32 v222, v1, 3, v222
    v_add_u32 v222, s54, v222
    s_mul_i32 s43, s3, 655360
    s_lshl_b32 s55, s50, 7
    s_add_u32 s43, s43, s55
    v_lshrrev_b32 v1, 3, v2
    v_lshlrev_b32 v223, 15, v1
    v_and_b32 v1, 7, v2
    v_lshl_add_u32 v223, v1, 4, v223
    v_add_u32 v223, s43, v223
    v_lshrrev_b32 v3, 5, v2
    v_mul_u32_u24 v116, 1216, v3
    v_add3_u32 v116, v116, v222, 64
    v_add_u32 v116, 192, v116
    v_mul_u32_u24 v117, 131064, v3
    v_sub_u32 v117, v223, v117
    v_add_u32 v117, 524288, v117
    s_lshl_b32 s43, s3, 5
    s_add_u32 s43, s43, s6
    s_lshl_b32 s43, s43, 7
    s_lshl_b32 s55, s47, 3
    s_add_u32 s43, s43, s55
    s_add_u32 s43, s43, 5242880
    v_mov_b32 v224, s43
    s_mov_b32 s42, 32768
    v_add_u32 v225, s42, v224
    s_mul_i32 s60, s58, 0x9E3779B1
    s_add_u32 s60, s60, 0x7F4A7C15
    s_mul_i32 s61, s59, 0x85EBCA6B
    s_add_u32 s61, s61, s60
    v_mov_b32 v228, s60
    v_mov_b32 v229, s61
    s_waitcnt vmcnt(9)
    v_and_b32 v100, v6, v217
    v_bfi_b32 v101, v6, v216, v217
    v_and_b32 v102, 0xffff, v216
    v_alignbit_b32 v103, v217, v217, 16
    v_alignbit_b32 v104, v216, v216, 16
    s_waitcnt vmcnt(8)
    v_and_b32 v105, v6, v219
    v_bfi_b32 v106, v6, v218, v219
    v_and_b32 v107, 0xffff, v218
    v_alignbit_b32 v108, v219, v219, 16
    v_alignbit_b32 v109, v218, v218, 16
    s_waitcnt vmcnt(7)
    v_and_b32 v110, v6, v221
    v_bfi_b32 v111, v6, v220, v221
    v_and_b32 v112, 0xffff, v220
    v_alignbit_b32 v113, v221, v221, 16
    v_alignbit_b32 v114, v220, v220, 16
    s_waitcnt vmcnt(0)
    ds_read_b64_tr_b16 v[120:121], v222 offset:0
    ds_read_b64_tr_b16 v[122:123], v222 offset:1280
    ds_read_b64_tr_b16 v[124:125], v222 offset:2560
    ds_read_b64_tr_b16 v[126:127], v222 offset:3840
    ds_read_b64_tr_b16 v[128:129], v222 offset:5120
    ds_read_b64_tr_b16 v[130:131], v222 offset:128
    ds_read_b64_tr_b16 v[132:133], v222 offset:1408
    ds_read_b64_tr_b16 v[134:135], v222 offset:2688
    ds_read_b64_tr_b16 v[136:137], v222 offset:3968
    ds_read_b64_tr_b16 v[138:139], v222 offset:5248
    ds_read_b64_tr_b16 v[140:141], v116 offset:0
    ds_read_b64_tr_b16 v[142:143], v116 offset:1280
    ds_read_b64_tr_b16 v[146:147], v116 offset:3840
    s_waitcnt lgkmcnt(12)
    v_dot2_f32_bf16 v36, v120, v100, 0
    v_dot2_f32_bf16 v37, v121, v103, 0
    v_dot2_f32_bf16 v38, v121, v100, 0
    s_waitcnt lgkmcnt(11)
    v_dot2_f32_bf16 v39, v122, v103, 0
    v_dot2_f32_bf16 v40, v122, v100, 0
    v_dot2_f32_bf16 v41, v123, v103, 0
    v_dot2_f32_bf16 v42, v123, v100, 0
    s_waitcnt lgkmcnt(10)
    v_dot2_f32_bf16 v43, v124, v103, 0
    v_dot2_f32_bf16 v36, v121, v101, v36
    v_dot2_f32_bf16 v37, v122, v104, v37
    v_dot2_f32_bf16 v38, v122, v101, v38
    v_dot2_f32_bf16 v39, v123, v104, v39
    v_dot2_f32_bf16 v40, v123, v101, v40
    v_dot2_f32_bf16 v41, v124, v104, v41
    v_dot2_f32_bf16 v42, v124, v101, v42
    v_dot2_f32_bf16 v43, v125, v104, v43
    v_dot2_f32_bf16 v36, v122, v102, v36
    v_dot2_f32_bf16 v38, v123, v102, v38
    v_dot2_f32_bf16 v40, v124, v102, v40
    v_dot2_f32_bf16 v42, v125, v102, v42
    s_waitcnt lgkmcnt(9)
    v_lshlrev_b32 v150, 16, v126
    v_and_b32 v151, v6, v126
    v_lshlrev_b32 v152, 16, v127
    v_and_b32 v153, v6, v127
    s_waitcnt lgkmcnt(8)
    v_lshlrev_b32 v154, 16, v128
    v_and_b32 v155, v6, v128
    v_lshlrev_b32 v156, 16, v129
    v_and_b32 v157, v6, v129
    v_pk_mul_f32 v[36:37], v[36:37], v[150:151]
    v_pk_mul_f32 v[38:39], v[38:39], v[152:153]
    v_pk_mul_f32 v[40:41], v[40:41], v[154:155]
    v_pk_mul_f32 v[42:43], v[42:43], v[156:157]
    v_cvt_pk_bf16_f32 v232, v36, v37
    v_cvt_pk_bf16_f32 v233, v38, v39
    v_cvt_pk_bf16_f32 v234, v40, v41
    v_cvt_pk_bf16_f32 v235, v42, v43
    buffer_store_dwordx4 v[232:235], v223, s[36:39], 0 offen sc1
    s_waitcnt lgkmcnt(7)
    v_dot2_f32_bf16 v36, v130, v105, 0
    v_dot2_f32_bf16 v37, v131, v108, 0
    v_dot2_f32_bf16 v38, v131, v105, 0
    s_waitcnt lgkmcnt(6)
    v_dot2_f32_bf16 v39, v132, v108, 0
    v_dot2_f32_bf16 v40, v132, v105, 0
    v_dot2_f32_bf16 v41, v133, v108, 0
    v_dot2_f32_bf16 v42, v133, v105, 0
    s_waitcnt lgkmcnt(5)
    v_dot2_f32_bf16 v43, v134, v108, 0
    v_dot2_f32_bf16 v36, v131, v106, v36
    v_dot2_f32_bf16 v37, v132, v109, v37
    v_dot2_f32_bf16 v38, v132, v106, v38
    v_dot2_f32_bf16 v39, v133, v109, v39
    v_dot2_f32_bf16 v40, v133, v106, v40
    v_dot2_f32_bf16 v41, v134, v109, v41
    v_dot2_f32_bf16 v42, v134, v106, v42
    v_dot2_f32_bf16 v43, v135, v109, v43
    v_dot2_f32_bf16 v36, v132, v107, v36
    v_dot2_f32_bf16 v38, v133, v107, v38
    v_dot2_f32_bf16 v40, v134, v107, v40
    v_dot2_f32_bf16 v42, v135, v107, v42
    s_waitcnt lgkmcnt(4)
    v_lshlrev_b32 v150, 16, v136
    v_and_b32 v151, v6, v136
    v_lshlrev_b32 v152, 16, v137
    v_and_b32 v153, v6, v137
    s_waitcnt lgkmcnt(3)
    v_lshlrev_b32 v154, 16, v138
    v_and_b32 v155, v6, v138
    v_lshlrev_b32 v156, 16, v139
    v_and_b32 v157, v6, v139
    v_pk_mul_f32 v[36:37], v[36:37], v[150:151]
    v_pk_mul_f32 v[38:39], v[38:39], v[152:153]
    v_pk_mul_f32 v[40:41], v[40:41], v[154:155]
    v_pk_mul_f32 v[42:43], v[42:43], v[156:157]
    v_cvt_pk_bf16_f32 v236, v36, v37
    v_cvt_pk_bf16_f32 v237, v38, v39
    v_cvt_pk_bf16_f32 v238, v40, v41
    v_cvt_pk_bf16_f32 v239, v42, v43
    s_mov_b32 s43, 262144
    buffer_store_dwordx4 v[236:239], v223, s[36:39], s43 offen sc1
    s_waitcnt lgkmcnt(2)
    v_dot2_f32_bf16 v36, v140, v110, 0
    v_dot2_f32_bf16 v37, v141, v113, 0
    v_dot2_f32_bf16 v38, v141, v110, 0
    s_waitcnt lgkmcnt(1)
    v_dot2_f32_bf16 v39, v142, v113, 0
    v_dot2_f32_bf16 v36, v141, v111, v36
    v_dot2_f32_bf16 v37, v142, v114, v37
    v_dot2_f32_bf16 v38, v142, v111, v38
    v_dot2_f32_bf16 v39, v143, v114, v39
    v_dot2_f32_bf16 v36, v142, v112, v36
    v_dot2_f32_bf16 v38, v143, v112, v38
    s_waitcnt lgkmcnt(0)
    v_lshlrev_b32 v150, 16, v146
    v_and_b32 v151, v6, v146
    v_lshlrev_b32 v152, 16, v147
    v_and_b32 v153, v6, v147
    v_pk_mul_f32 v[36:37], v[36:37], v[150:151]
    v_pk_mul_f32 v[38:39], v[38:39], v[152:153]
    v_cvt_pk_bf16_f32 v240, v36, v37
    v_cvt_pk_bf16_f32 v241, v38, v39
    buffer_store_dwordx2 v[240:241], v117, s[36:39], 0 offen sc1
    s_mov_b32 s20, s8
    s_mov_b32 s21, s9
    s_mov_b32 s22, 2621440
    s_mov_b32 s23, 0x20000
    s_waitcnt vmcnt(0)
    s_mov_b64 exec, 1
    buffer_store_dwordx2 v[228:229], v224, s[36:39], 0 offen
    s_mov_b64 exec, -1
    v_lshrrev_b32 v1, 2, v2
    v_mul_u32_u24 v1, 1280, v1
    v_and_b32 v14, 3, v2
    v_lshlrev_b32 v14, 7, v14
    v_min_u32 v14, 316, v14
    v_add_u32 v1, v1, v14
    s_lshl_b32 s43, s6, 2
    s_and_b32 s66, s47, 3
    s_add_u32 s43, s43, s66
    s_mul_i32 s43, s43, 20480
    s_add_u32 s43, s43, s48
    buffer_load_dword v14, v1, s[20:23], s43 offen
    s_mov_b64 exec, 1
    buffer_store_dwordx2 v[228:229], v225, s[36:39], 0 offen sc1
    s_mov_b64 exec, -1
L_fin:
L_end:
    s_endpgm
.section .rodata,"a"
.p2align 6
.amdhsa_kernel concat_heads__ssm_conv_h3__ssm_conv_h3__prompt_kernel
  .amdhsa_next_free_vgpr 256
  .amdhsa_next_free_sgpr 102
  .amdhsa_accum_offset 256
  .amdhsa_group_segment_fixed_size 0
  .amdhsa_kernarg_size 120
  .amdhsa_user_sgpr_count 2
  .amdhsa_user_sgpr_kernarg_segment_ptr 1
  .amdhsa_system_sgpr_workgroup_id_x 1
  .amdhsa_float_denorm_mode_32 3
.end_amdhsa_kernel
```
